```python
import torch

def _softmax(x, axis=-1):
    return torch.softmax(x, dim=axis)
def _gelu(x):
    return torch.nn.functional.gelu(x, approximate="tanh")
def _silu(x):
    return torch.nn.functional.silu(x)
def _sigmoid(x):
    return torch.sigmoid(x)
def _layernorm(x, axis=-1, eps=1e-5):
    m = x.mean(dim=axis, keepdim=True)
    v = x.var(dim=axis, keepdim=True, unbiased=False)
    return (x - m) / torch.sqrt(v + eps)
def _scatter_add(tgt, idx, src, axis=0):
    return tgt.clone().index_add_(axis, idx, src)
def _segment_sum(src, seg, n):
    out = torch.zeros((n,) + src.shape[1:], dtype=src.dtype)
    return out.index_add_(0, seg, src)
def _pad(x, pw):
    flat = tuple(v for pair in reversed(pw) for v in pair)
    return torch.nn.functional.pad(x, flat)

kernel_name = 'concat_heads__sliding_block__sliding_block__prompt'

def setup_inputs():

    _w = (lambda a: (lambda t: t.to(torch.bfloat16) if t.is_floating_point() else t)(torch.as_tensor(a)))
    def _A_setup():
        B, S, D = 1, 2048, 576
        return {
            "x": _w((lambda *s: torch.randn(*s, dtype=torch.bfloat16) * 0.2)(B, S, D)),
            "wqkv": _w((lambda *s: torch.randn(*s, dtype=torch.bfloat16) * 0.2)(D, 3 * D)),
            "wo": _w((lambda *s: torch.randn(*s, dtype=torch.bfloat16) * 0.05)(D, D)),
        }
    _A_in = _A_setup()

    def _B_setup():
        B, S, D = 1, 2048, 576
        return {
            "x": _w((lambda *s: torch.randn(*s, dtype=torch.bfloat16) * 0.2)(B, S, D)),
            "wqkv": _w((lambda *s: torch.randn(*s, dtype=torch.bfloat16) * 0.2)(D, 3 * D)),
            "wo": _w((lambda *s: torch.randn(*s, dtype=torch.bfloat16) * 0.05)(D, D)),
        }
    _B_in = _B_setup()

    return {
        "A_x": _A_in["x"],
        "A_wqkv": _A_in["wqkv"],
        "A_wo": _A_in["wo"],
        "B_x": _B_in["x"],
        "B_wqkv": _B_in["wqkv"],
        "B_wo": _B_in["wo"],
    }

def reference(A_x, A_wqkv, A_wo, B_x, B_wqkv, B_wo):
    def _A_ref(x, wqkv, wo):
        B, S, D = x.shape
        H = 32; Dh = D // H; W = 256
        qkv = (lambda x, *d: x.permute(*d))((x @ wqkv).reshape(B, S, 3, H, Dh), 2, 0, 3, 1, 4)
        q, k, v = qkv[0], qkv[1], qkv[2]
        scores = torch.einsum("bhqd,bhkd->bhqk", q, k) * (Dh ** -0.5)
        idx = torch.arange(S)
        mask = (idx[:, None] - idx[None, :] >= 0) & (idx[:, None] - idx[None, :] < W)
        scores = torch.where(mask[None, None], scores, -1e9)
        p = _softmax(scores, axis=-1)
        o = torch.einsum("bhqk,bhkd->bhqd", p, v)
        return (lambda x, *d: x.permute(*d))(o, 0, 2, 1, 3).reshape(B, S, D) @ wo

    def _B_ref(x, wqkv, wo):
        B, S, D = x.shape
        H = 32; Dh = D // H; W = 256
        qkv = (lambda x, *d: x.permute(*d))((x @ wqkv).reshape(B, S, 3, H, Dh), 2, 0, 3, 1, 4)
        q, k, v = qkv[0], qkv[1], qkv[2]
        scores = torch.einsum("bhqd,bhkd->bhqk", q, k) * (Dh ** -0.5)
        idx = torch.arange(S)
        mask = (idx[:, None] - idx[None, :] >= 0) & (idx[:, None] - idx[None, :] < W)
        scores = torch.where(mask[None, None], scores, -1e9)
        p = _softmax(scores, axis=-1)
        o = torch.einsum("bhqk,bhkd->bhqd", p, v)
        return (lambda x, *d: x.permute(*d))(o, 0, 2, 1, 3).reshape(B, S, D) @ wo

    a = _A_ref(A_x, A_wqkv, A_wo)
    b = _B_ref(B_x, B_wqkv, B_wo)
    return torch.concatenate([a, b], axis=-1)
```

```asm
; @launch grid=(256,1,1) block=(256,1,1) lds=163840
.amdgcn_target "amdgcn-amd-amdhsa--gfx950"
.text
.globl concat_heads__sliding_block__sliding_block__prompt_kernel
.p2align 8
.type concat_heads__sliding_block__sliding_block__prompt_kernel,@function
concat_heads__sliding_block__sliding_block__prompt_kernel:
    s_load_dwordx8 s[36:43], s[0:1], 0
    s_load_dwordx8 s[44:51], s[0:1], 32
    s_load_dwordx2 s[52:53], s[0:1], 64
    s_cmp_ge_u32 s2, 256
    s_cbranch_scc1 L_end
    s_getpc_b64 s[4:5]
L_pc:
    v_lshlrev_b32 v2, 7, v0
    v_min_u32 v2, (L_end-L_pc), v2
    global_load_dword v255, v2, s[4:5]
    v_and_b32 v1, 63, v0
    v_lshrrev_b32 v2, 6, v0
    s_and_b32 s3, s2, 7
    v_readfirstlane_b32 s35, v2
    s_lshr_b32 s32, s3, 2
    s_lshr_b32 s4, s2, 3
    s_and_b32 s5, s3, 3
    s_lshl_b32 s33, s5, 2
    s_lshr_b32 s5, s4, 3
    s_add_u32 s33, s33, s5
    s_and_b32 s34, s4, 7
    s_lshl_b32 s5, s5, 1
    s_add_u32 s6, s5, s34
    s_sub_u32 s7, s6, 9
    s_cmp_ge_u32 s6, 9
    s_cselect_b32 s70, s7, s6
    s_add_u32 s81, s5, s34
    s_and_b32 s81, s81, 7
    s_and_b32 s6, s3, 3
    s_lshl_b32 s6, s6, 1
    s_and_b32 s7, s33, 1
    s_add_u32 s70, s6, s7
    s_mov_b32 s76, s81
    s_lshl_b32 s6, s33, 7
    s_lshl_b32 s7, s35, 5
    s_add_u32 s6, s6, s7
    s_mul_i32 s6, s6, 1152
    v_lshrrev_b32 v4, 3, v1
    v_lshrrev_b32 v5, 4, v1
    v_and_b32 v6, 7, v1
    v_mul_u32_u24 v4, 1152, v4
    v_add_u32 v4, s6, v4
    v_add_u32 v7, 0, v5
    v_and_b32 v7, 7, v7
    v_xor_b32 v7, v6, v7
    v_lshl_add_u32 v7, v7, 4, v4
    v_add_u32 v15, 0, v7
    v_add_u32 v7, 4, v5
    v_and_b32 v7, 7, v7
    v_xor_b32 v7, v6, v7
    v_lshl_add_u32 v7, v7, 4, v4
    v_add_u32 v16, 8192, v7
    v_add_u32 v7, 8, v5
    v_and_b32 v7, 7, v7
    v_xor_b32 v7, v6, v7
    v_lshl_add_u32 v7, v7, 4, v4
    v_add_u32 v17, 16384, v7
    v_add_u32 v7, 12, v5
    v_and_b32 v7, 7, v7
    v_xor_b32 v7, v6, v7
    v_lshl_add_u32 v7, v7, 4, v4
    v_add_u32 v18, 24576, v7
    s_waitcnt lgkmcnt(0)
    s_cmp_eq_u32 s32, 0
    s_cselect_b32 s8, s36, s42
    s_cselect_b32 s9, s37, s43
    s_cselect_b32 s12, s38, s44
    s_cselect_b32 s13, s39, s45
    s_mov_b32 s10, 2359296
    s_mov_b32 s11, 0x00020000
    s_mov_b32 s14, 1990656
    s_mov_b32 s15, 0x00020000
    s_cselect_b32 s16, s40, s46
    s_cselect_b32 s17, s41, s47
    s_mov_b32 s58, s70
    s_mul_i32 s59, s58, 221184
    s_lshl_b32 s60, s58, 7
    s_lshl_b32 s61, s35, 12
    s_add_u32 m0, s61, 20480
    s_nop 0
    buffer_load_dwordx4 v15, s[8:11], s60 offen offset:0 lds
    buffer_load_dwordx4 v16, s[8:11], s60 offen offset:1024 lds
    buffer_load_dwordx4 v17, s[8:11], s60 offen offset:2048 lds
    buffer_load_dwordx4 v18, s[8:11], s60 offen offset:3072 lds
    s_mul_i32 s6, s35, 55296
    s_mul_i32 s7, s34, 144
    s_add_u32 s6, s6, s7
    s_add_u32 s6, s6, 1152
    s_movk_i32 s7, 3456
    v_mov_b32 v9, 0x40000000
    v_mov_b32 v8, 1008
    v_add_u32 v4, 0, v1
    v_mul_u32_u24 v5, 52429, v4
    v_lshrrev_b32 v5, 20, v5
    v_mul_u32_u24 v6, 20, v5
    v_sub_u32 v6, v4, v6
    v_cmp_lt_u32 vcc, 8, v6
    v_mul_lo_u32 v5, v5, s7
    v_lshl_add_u32 v5, v6, 4, v5
    v_cndmask_b32 v7, 0, v8, vcc
    v_cmp_lt_u32 vcc, 17, v6
    v_add3_u32 v5, v5, v7, s6
    s_nop 0
    v_cndmask_b32 v10, v5, v9, vcc
    v_add_u32 v4, 64, v1
    v_mul_u32_u24 v5, 52429, v4
    v_lshrrev_b32 v5, 20, v5
    v_mul_u32_u24 v6, 20, v5
    v_sub_u32 v6, v4, v6
    v_cmp_lt_u32 vcc, 8, v6
    v_mul_lo_u32 v5, v5, s7
    v_lshl_add_u32 v5, v6, 4, v5
    v_cndmask_b32 v7, 0, v8, vcc
    v_cmp_lt_u32 vcc, 17, v6
    v_add3_u32 v5, v5, v7, s6
    v_subrev_u32 v5, 1024, v5
    v_cndmask_b32 v11, v5, v9, vcc
    v_add_u32 v4, 128, v1
    v_mul_u32_u24 v5, 52429, v4
    v_lshrrev_b32 v5, 20, v5
    v_mul_u32_u24 v6, 20, v5
    v_sub_u32 v6, v4, v6
    v_cmp_lt_u32 vcc, 8, v6
    v_mul_lo_u32 v5, v5, s7
    v_lshl_add_u32 v5, v6, 4, v5
    v_cndmask_b32 v7, 0, v8, vcc
    v_cmp_lt_u32 vcc, 17, v6
    v_add3_u32 v5, v5, v7, s6
    v_subrev_u32 v5, 2048, v5
    v_cndmask_b32 v12, v5, v9, vcc
    v_add_u32 v4, 192, v1
    v_mul_u32_u24 v5, 52429, v4
    v_lshrrev_b32 v5, 20, v5
    v_mul_u32_u24 v6, 20, v5
    v_sub_u32 v6, v4, v6
    v_cmp_lt_u32 vcc, 8, v6
    v_mul_lo_u32 v5, v5, s7
    v_lshl_add_u32 v5, v6, 4, v5
    v_cndmask_b32 v7, 0, v8, vcc
    v_cmp_lt_u32 vcc, 17, v6
    v_add3_u32 v5, v5, v7, s6
    v_subrev_u32 v5, 3072, v5
    v_cndmask_b32 v13, v5, v9, vcc
    v_add_u32 v4, 256, v1
    v_mul_u32_u24 v5, 52429, v4
    v_lshrrev_b32 v5, 20, v5
    v_mul_u32_u24 v6, 20, v5
    v_sub_u32 v6, v4, v6
    v_cmp_lt_u32 vcc, 8, v6
    v_mul_lo_u32 v5, v5, s7
    v_lshl_add_u32 v5, v6, 4, v5
    v_cndmask_b32 v7, 0, v8, vcc
    v_cmp_lt_u32 vcc, 17, v6
    v_add3_u32 v5, v5, v7, s6
    s_nop 0
    v_cndmask_b32 v14, v5, v9, vcc
    v_bfe_u32 v4, v1, 2, 2
    v_lshrrev_b32 v5, 5, v1
    v_lshl_add_u32 v4, v5, 3, v4
    v_bfe_u32 v6, v1, 4, 1
    v_and_b32 v7, 3, v1
    v_mul_u32_u24 v8, 320, v4
    v_lshlrev_b32 v9, 5, v6
    v_lshl_add_u32 v9, v7, 3, v9
    v_add_u32 v22, v8, v9
    v_add_u32 v23, 73728, v22
    v_mul_u32_u24 v2, 192, v4
    v_add3_u32 v34, v2, v9, 0
    v_add_u32 v34, 36864, v34
    v_lshrrev_b32 v3, 1, v7
    v_cmp_eq_u32 vcc, v3, v6
    v_and_b32 v3, 1, v7
    v_lshlrev_b32 v3, 3, v3
    v_add_u32 v3, 128, v3
    v_add_u32 v43, 32, v3
    v_cndmask_b32 v3, v43, v3, vcc
    v_add3_u32 v43, v2, v3, 0
    v_add_u32 v43, 36864, v43
    v_lshl_add_u32 v9, v6, 2, v7
    v_lshlrev_b32 v2, 3, v9
    v_add_u32 v2, 128, v2
    v_add_u32 v3, 128, v2
    v_cmp_lt_u32 vcc, 1, v9
    s_nop 1
    v_cndmask_b32 v2, v2, v3, vcc
    v_add_u32 v24, v8, v2
    v_add_u32 v25, 73728, v24
    v_and_b32 v2, 31, v1
    v_bfe_u32 v3, v1, 1, 3
    v_xor_b32 v3, v3, v5
    v_lshlrev_b32 v3, 4, v3
    v_lshl_add_u32 v3, v2, 7, v3
    s_lshl_b32 s6, s35, 12
    s_add_u32 s6, s6, 20480
    v_add_u32 v3, s6, v3
    v_xor_b32 v26, 0, v3
    v_add_u32 v30, 73728, v26
    v_xor_b32 v27, 32, v3
    v_add_u32 v31, 73728, v27
    v_xor_b32 v28, 64, v3
    v_add_u32 v32, 73728, v28
    v_xor_b32 v29, 96, v3
    v_add_u32 v33, 73728, v29
    s_mov_b32 s20, s48
    s_mov_b32 s21, s49
    s_mov_b32 s22, 4718592
    s_mov_b32 s23, 0x00020000
    s_mov_b32 s24, s52
    s_mov_b32 s25, s53
    s_mov_b32 s26, 67108864
    s_mov_b32 s27, 0x00020000
    s_mov_b32 s28, s50
    s_mov_b32 s29, s51
    s_mov_b32 s30, 256
    s_mov_b32 s31, 0x00020000
    s_mov_b32 s18, 663552
    s_mov_b32 s19, 0x00020000
    s_or_b32 s3, s2, s35
    s_cmp_lg_u32 s3, 0
    s_cbranch_scc1 L_nononce
    s_memrealtime s[4:5]
    s_waitcnt lgkmcnt(0)
    s_or_b32 s4, s4, 1
    v_mov_b32 v2, s4
    v_mov_b32 v3, s5
    v_mov_b32 v4, 0
    s_mov_b64 exec, 1
    buffer_store_dwordx2 v[2:3], v4, s[28:31], 0 offen sc1
    s_mov_b64 exec, -1
L_nononce:
    s_mul_i32 s61, s35, 5120
    s_add_u32 m0, s61, 0
    s_nop 0
    buffer_load_dwordx4 v10, s[12:15], s59 offen offset:0 lds
    buffer_load_dwordx4 v11, s[12:15], s59 offen offset:1024 lds
    buffer_load_dwordx4 v12, s[12:15], s59 offen offset:2048 lds
    buffer_load_dwordx4 v13, s[12:15], s59 offen offset:3072 lds
    s_add_u32 m0, s61, 4096
    s_nop 0
    buffer_load_dwordx4 v14, s[12:15], s59 offen lds
    s_add_u32 s58, s70, s76
    s_add_u32 s58, s58, 1
    s_sub_u32 s67, s58, 9
    s_cmp_ge_u32 s58, 9
    s_cselect_b32 s58, s67, s58
    s_add_u32 s76, s76, 1
    s_and_b32 s76, s76, 7
    s_mul_i32 s59, s58, 221184
    s_lshl_b32 s60, s58, 7
    v_mul_u32_u24 v226, 7282, v1
    v_lshrrev_b32 v226, 16, v226
    v_mul_u32_u24 v227, 9, v226
    v_sub_u32 v227, v1, v227
    v_min_u32 v226, 3, v226
    s_lshl_b32 s63, s33, 7
    s_lshl_b32 s64, s34, 4
    s_add_u32 s63, s63, s64
    s_lshl_b32 s64, s35, 2
    s_add_u32 s63, s63, s64
    v_add_u32 v226, s63, v226
    v_mul_u32_u24 v226, 1152, v226
    v_lshl_add_u32 v226, v227, 7, v226
    s_mov_b32 exec_hi, 15
    buffer_load_dword v255, v226, s[8:11], 0 offen
    s_mov_b64 exec, -1
    s_waitcnt vmcnt(1)
    s_barrier
    ds_read_b128 a[0:3], v26 offset:0
    ds_read_b64_tr_b16 v[52:53], v22 offset:0
    ds_read_b64_tr_b16 v[54:55], v22 offset:1280
    ds_read_b64_tr_b16 v[56:57], v22 offset:64
    ds_read_b64_tr_b16 v[58:59], v22 offset:1344
    ds_read_b64_tr_b16 v[60:61], v22 offset:144
    ds_read_b64_tr_b16 v[62:63], v22 offset:1424
    ds_read_b64_tr_b16 v[64:65], v22 offset:208
    ds_read_b64_tr_b16 v[66:67], v22 offset:1488
    ds_read_b64_tr_b16 v[68:69], v24 offset:0
    ds_read_b64_tr_b16 v[70:71], v24 offset:1280
    s_waitcnt lgkmcnt(8)
    v_mfma_f32_32x32x16_bf16 v[92:107], v[52:55], a[0:3], 0
    ds_read_b128 a[4:7], v27 offset:0
    ds_read_b64_tr_b16 v[72:73], v22 offset:5120
    ds_read_b64_tr_b16 v[74:75], v22 offset:6400
    s_lshl_b32 s61, s35, 12
    s_add_u32 m0, s61, 57344
    s_nop 0
    buffer_load_dwordx4 v15, s[8:11], s60 offen offset:0 lds
    s_waitcnt lgkmcnt(9)
    v_mfma_f32_32x32x16_bf16 v[108:123], v[56:59], a[0:3], 0
    ds_read_b64_tr_b16 v[76:77], v22 offset:5184
    ds_read_b64_tr_b16 v[78:79], v22 offset:6464
    buffer_load_dwordx4 v16, s[8:11], s60 offen offset:1024 lds
    s_waitcnt lgkmcnt(9)
    v_mfma_f32_32x32x16_bf16 v[124:139], a[0:3], v[60:63], 0
    ds_read_b64_tr_b16 v[80:81], v22 offset:5264
    ds_read_b64_tr_b16 v[82:83], v22 offset:6544
    buffer_load_dwordx4 v17, s[8:11], s60 offen offset:2048 lds
    s_waitcnt lgkmcnt(9)
    v_mfma_f32_32x32x16_bf16 v[140:155], a[0:3], v[64:67], 0
    ds_read_b64_tr_b16 v[84:85], v22 offset:5328
    ds_read_b64_tr_b16 v[86:87], v22 offset:6608
    buffer_load_dwordx4 v18, s[8:11], s60 offen offset:3072 lds
    s_waitcnt lgkmcnt(9)
    v_mfma_f32_32x32x16_bf16 v[156:171], v[68:71], a[0:3], 0
    ds_read_b64_tr_b16 v[88:89], v24 offset:5120
    ds_read_b64_tr_b16 v[90:91], v24 offset:6400
    s_mul_i32 s61, s35, 5120
    s_add_u32 m0, s61, 36864
    s_nop 0
    buffer_load_dwordx4 v10, s[12:15], s59 offen offset:0 lds
    s_waitcnt lgkmcnt(8)
    v_mfma_f32_32x32x16_bf16 v[92:107], v[72:75], a[4:7], v[92:107]
    ds_read_b128 a[8:11], v28 offset:0
    ds_read_b64_tr_b16 v[52:53], v22 offset:10240
    ds_read_b64_tr_b16 v[54:55], v22 offset:11520
    buffer_load_dwordx4 v11, s[12:15], s59 offen offset:1024 lds
    s_waitcnt lgkmcnt(9)
    v_mfma_f32_32x32x16_bf16 v[108:123], v[76:79], a[4:7], v[108:123]
    ds_read_b64_tr_b16 v[56:57], v22 offset:10304
    ds_read_b64_tr_b16 v[58:59], v22 offset:11584
    buffer_load_dwordx4 v12, s[12:15], s59 offen offset:2048 lds
    s_waitcnt lgkmcnt(9)
    v_mfma_f32_32x32x16_bf16 v[124:139], a[4:7], v[80:83], v[124:139]
    ds_read_b64_tr_b16 v[60:61], v22 offset:10384
    ds_read_b64_tr_b16 v[62:63], v22 offset:11664
    buffer_load_dwordx4 v13, s[12:15], s59 offen offset:3072 lds
    s_waitcnt lgkmcnt(9)
    v_mfma_f32_32x32x16_bf16 v[140:155], a[4:7], v[84:87], v[140:155]
    ds_read_b64_tr_b16 v[64:65], v22 offset:10448
    ds_read_b64_tr_b16 v[66:67], v22 offset:11728
    s_add_u32 m0, s61, 40960
    s_nop 0
    buffer_load_dwordx4 v14, s[12:15], s59 offen lds
    s_add_u32 s58, s70, s76
    s_add_u32 s58, s58, 1
    s_sub_u32 s67, s58, 9
    s_cmp_ge_u32 s58, 9
    s_cselect_b32 s58, s67, s58
    s_add_u32 s76, s76, 1
    s_and_b32 s76, s76, 7
    s_mul_i32 s59, s58, 221184
    s_lshl_b32 s60, s58, 7
    s_waitcnt lgkmcnt(9)
    v_mfma_f32_32x32x16_bf16 v[156:171], v[88:91], a[4:7], v[156:171]
    ds_read_b64_tr_b16 v[68:69], v24 offset:10240
    ds_read_b64_tr_b16 v[70:71], v24 offset:11520
    s_lshl_b32 s61, s35, 12
    s_add_u32 m0, s61, 94208
    s_nop 0
    buffer_load_dwordx4 v15, s[8:11], s60 offen offset:0 lds
    s_waitcnt lgkmcnt(8)
    v_mfma_f32_32x32x16_bf16 v[92:107], v[52:55], a[8:11], v[92:107]
    ds_read_b128 a[12:15], v29 offset:0
    ds_read_b64_tr_b16 v[72:73], v22 offset:15360
    ds_read_b64_tr_b16 v[74:75], v22 offset:16640
    s_mov_b32 s54, 0x3ffff
    s_mov_b32 s55, 0x3ffff
    s_not_b64 s[52:53], s[54:55]
    s_mov_b32 s56, -1
    s_mov_b32 s57, 0
    s_waitcnt lgkmcnt(9)
    v_mfma_f32_32x32x16_bf16 v[108:123], v[56:59], a[8:11], v[108:123]
    ds_read_b64_tr_b16 v[76:77], v22 offset:15424
    ds_read_b64_tr_b16 v[78:79], v22 offset:16704
    buffer_load_dwordx4 v16, s[8:11], s60 offen offset:1024 lds
    s_waitcnt lgkmcnt(9)
    v_mfma_f32_32x32x16_bf16 v[124:139], a[8:11], v[60:63], v[124:139]
    ds_read_b64_tr_b16 v[80:81], v22 offset:15504
    ds_read_b64_tr_b16 v[82:83], v22 offset:16784
    s_mov_b32 s80, 0x3eae1a93
    s_getreg_b32 s73, hwreg(HW_REG_XCC_ID, 0, 4)
    s_mul_i32 s6, s35, 55296
    s_mul_i32 s7, s34, 144
    s_add_u32 s6, s6, s7
    s_waitcnt lgkmcnt(9)
    v_mfma_f32_32x32x16_bf16 v[140:155], a[8:11], v[64:67], v[140:155]
    ds_read_b64_tr_b16 v[84:85], v22 offset:15568
    ds_read_b64_tr_b16 v[86:87], v22 offset:16848
    buffer_load_dwordx4 v17, s[8:11], s60 offen offset:2048 lds
    s_waitcnt lgkmcnt(9)
    v_mfma_f32_32x32x16_bf16 v[156:171], v[68:71], a[8:11], v[156:171]
    ds_read_b64_tr_b16 v[88:89], v24 offset:15360
    ds_read_b64_tr_b16 v[90:91], v24 offset:16640
    s_movk_i32 s7, 3456
    v_mov_b32 v9, 0x40000000
    v_add_u32 v4, 0, v1
    v_mul_u32_u24 v5, 21846, v4
    v_lshrrev_b32 v5, 18, v5
    s_waitcnt vmcnt(3)
    s_barrier
    s_waitcnt lgkmcnt(8)
    v_mfma_f32_32x32x16_bf16 v[92:107], v[72:75], a[12:15], v[92:107]
    ds_read_b128 a[16:19], v26 offset:36864
    ds_read_b64_tr_b16 v[52:53], v22 offset:36864
    ds_read_b64_tr_b16 v[54:55], v22 offset:38144
    buffer_load_dwordx4 v18, s[8:11], s60 offen offset:3072 lds
    s_waitcnt lgkmcnt(9)
    v_mfma_f32_32x32x16_bf16 v[108:123], v[76:79], a[12:15], v[108:123]
    ds_read_b64_tr_b16 v[56:57], v22 offset:36928
    ds_read_b64_tr_b16 v[58:59], v22 offset:38208
    s_mul_i32 s61, s35, 5120
    s_add_u32 m0, s61, 73728
    s_nop 0
    buffer_load_dwordx4 v10, s[12:15], s59 offen offset:0 lds
    s_waitcnt lgkmcnt(9)
    v_mfma_f32_32x32x16_bf16 v[124:139], a[12:15], v[80:83], v[124:139]
    ds_read_b64_tr_b16 v[60:61], v22 offset:37008
    ds_read_b64_tr_b16 v[62:63], v22 offset:38288
    buffer_load_dwordx4 v11, s[12:15], s59 offen offset:1024 lds
    s_waitcnt lgkmcnt(9)
    v_mfma_f32_32x32x16_bf16 v[140:155], a[12:15], v[84:87], v[140:155]
    ds_read_b64_tr_b16 v[64:65], v22 offset:37072
    ds_read_b64_tr_b16 v[66:67], v22 offset:38352
    buffer_load_dwordx4 v12, s[12:15], s59 offen offset:2048 lds
    s_waitcnt lgkmcnt(9)
    v_mfma_f32_32x32x16_bf16 v[156:171], v[88:91], a[12:15], v[156:171]
    ds_read_b64_tr_b16 v[68:69], v24 offset:36864
    ds_read_b64_tr_b16 v[70:71], v24 offset:38144
    buffer_load_dwordx4 v13, s[12:15], s59 offen offset:3072 lds
    s_waitcnt lgkmcnt(8)
    v_mfma_f32_32x32x16_bf16 v[92:107], v[52:55], a[16:19], v[92:107]
    ds_read_b128 a[20:23], v27 offset:36864
    ds_read_b64_tr_b16 v[72:73], v22 offset:41984
    ds_read_b64_tr_b16 v[74:75], v22 offset:43264
    s_add_u32 m0, s61, 77824
    s_nop 0
    buffer_load_dwordx4 v14, s[12:15], s59 offen lds
    s_add_u32 s58, s70, s76
    s_add_u32 s58, s58, 1
    s_sub_u32 s67, s58, 9
    s_cmp_ge_u32 s58, 9
    s_cselect_b32 s58, s67, s58
    s_add_u32 s76, s76, 1
    s_and_b32 s76, s76, 7
    s_mul_i32 s59, s58, 221184
    s_lshl_b32 s60, s58, 7
    s_waitcnt lgkmcnt(9)
    v_mfma_f32_32x32x16_bf16 v[108:123], v[56:59], a[16:19], v[108:123]
    ds_read_b64_tr_b16 v[76:77], v22 offset:42048
    ds_read_b64_tr_b16 v[78:79], v22 offset:43328
    s_lshl_b32 s61, s35, 12
    s_add_u32 m0, s61, 131072
    s_nop 0
    buffer_load_dwordx4 v15, s[8:11], s60 offen offset:0 lds
    s_waitcnt lgkmcnt(9)
    v_mfma_f32_32x32x16_bf16 v[124:139], a[16:19], v[60:63], v[124:139]
    ds_read_b64_tr_b16 v[80:81], v22 offset:42128
    ds_read_b64_tr_b16 v[82:83], v22 offset:43408
    v_mul_u32_u24 v6, 12, v5
    v_sub_u32 v6, v4, v6
    v_cmp_lt_u32 vcc, 8, v6
    v_mul_lo_u32 v5, v5, s7
    v_lshl_add_u32 v5, v6, 4, v5
    s_waitcnt lgkmcnt(9)
    v_mfma_f32_32x32x16_bf16 v[140:155], a[16:19], v[64:67], v[140:155]
    ds_read_b64_tr_b16 v[84:85], v22 offset:42192
    ds_read_b64_tr_b16 v[86:87], v22 offset:43472
    buffer_load_dwordx4 v16, s[8:11], s60 offen offset:1024 lds
    s_waitcnt lgkmcnt(9)
    v_mfma_f32_32x32x16_bf16 v[156:171], v[68:71], a[16:19], v[156:171]
    ds_read_b64_tr_b16 v[88:89], v24 offset:41984
    ds_read_b64_tr_b16 v[90:91], v24 offset:43264
    v_add_u32 v5, s6, v5
    v_subrev_u32 v5, 0, v5
    v_cndmask_b32 v19, v5, v9, vcc
    v_add_u32 v4, 64, v1
    v_mul_u32_u24 v5, 21846, v4
    s_waitcnt lgkmcnt(8)
    v_mfma_f32_32x32x16_bf16 v[92:107], v[72:75], a[20:23], v[92:107]
    ds_read_b128 a[24:27], v28 offset:36864
    ds_read_b64_tr_b16 v[52:53], v22 offset:47104
    ds_read_b64_tr_b16 v[54:55], v22 offset:48384
    buffer_load_dwordx4 v17, s[8:11], s60 offen offset:2048 lds
    s_waitcnt lgkmcnt(9)
    v_mfma_f32_32x32x16_bf16 v[108:123], v[76:79], a[20:23], v[108:123]
    ds_read_b64_tr_b16 v[56:57], v22 offset:47168
    ds_read_b64_tr_b16 v[58:59], v22 offset:48448
    v_lshrrev_b32 v5, 18, v5
    v_mul_u32_u24 v6, 12, v5
    v_sub_u32 v6, v4, v6
    v_cmp_lt_u32 vcc, 8, v6
    v_mul_lo_u32 v5, v5, s7
    s_waitcnt lgkmcnt(9)
    v_mfma_f32_32x32x16_bf16 v[124:139], a[20:23], v[80:83], v[124:139]
    ds_read_b64_tr_b16 v[60:61], v22 offset:47248
    ds_read_b64_tr_b16 v[62:63], v22 offset:48528
    buffer_load_dwordx4 v18, s[8:11], s60 offen offset:3072 lds
    s_waitcnt lgkmcnt(9)
    v_mfma_f32_32x32x16_bf16 v[140:155], a[20:23], v[84:87], v[140:155]
    ds_read_b64_tr_b16 v[64:65], v22 offset:47312
    ds_read_b64_tr_b16 v[66:67], v22 offset:48592
    v_lshl_add_u32 v5, v6, 4, v5
    v_add_u32 v5, s6, v5
    v_subrev_u32 v5, 1024, v5
    v_cndmask_b32 v20, v5, v9, vcc
    v_add_u32 v4, 128, v1
    s_waitcnt lgkmcnt(9)
    v_mfma_f32_32x32x16_bf16 v[156:171], v[88:91], a[20:23], v[156:171]
    ds_read_b64_tr_b16 v[68:69], v24 offset:47104
    ds_read_b64_tr_b16 v[70:71], v24 offset:48384
    s_mul_i32 s61, s35, 5120
    s_add_u32 m0, s61, 110592
    s_nop 0
    buffer_load_dwordx4 v10, s[12:15], s59 offen offset:0 lds
    s_waitcnt lgkmcnt(8)
    v_mfma_f32_32x32x16_bf16 v[92:107], v[52:55], a[24:27], v[92:107]
    ds_read_b128 a[28:31], v29 offset:36864
    ds_read_b64_tr_b16 v[72:73], v22 offset:52224
    ds_read_b64_tr_b16 v[74:75], v22 offset:53504
    v_mul_u32_u24 v5, 21846, v4
    v_lshrrev_b32 v5, 18, v5
    v_mul_u32_u24 v6, 12, v5
    v_sub_u32 v6, v4, v6
    v_cmp_lt_u32 vcc, 8, v6
    s_waitcnt lgkmcnt(9)
    v_mfma_f32_32x32x16_bf16 v[108:123], v[56:59], a[24:27], v[108:123]
    ds_read_b64_tr_b16 v[76:77], v22 offset:52288
    ds_read_b64_tr_b16 v[78:79], v22 offset:53568
    buffer_load_dwordx4 v11, s[12:15], s59 offen offset:1024 lds
    s_waitcnt lgkmcnt(9)
    v_mfma_f32_32x32x16_bf16 v[124:139], a[24:27], v[60:63], v[124:139]
    ds_read_b64_tr_b16 v[80:81], v22 offset:52368
    ds_read_b64_tr_b16 v[82:83], v22 offset:53648
    v_mul_lo_u32 v5, v5, s7
    v_lshl_add_u32 v5, v6, 4, v5
    v_add_u32 v5, s6, v5
    v_subrev_u32 v5, 2048, v5
    v_cndmask_b32 v21, v5, v9, vcc
    s_waitcnt lgkmcnt(9)
    v_mfma_f32_32x32x16_bf16 v[140:155], a[24:27], v[64:67], v[140:155]
    ds_read_b64_tr_b16 v[84:85], v22 offset:52432
    ds_read_b64_tr_b16 v[86:87], v22 offset:53712
    buffer_load_dwordx4 v12, s[12:15], s59 offen offset:2048 lds
    s_waitcnt lgkmcnt(9)
    v_mfma_f32_32x32x16_bf16 v[156:171], v[68:71], a[24:27], v[156:171]
    ds_read_b64_tr_b16 v[88:89], v24 offset:52224
    ds_read_b64_tr_b16 v[90:91], v24 offset:53504
    v_and_b32 v2, 31, v1
    v_lshrrev_b32 v5, 5, v1
    s_mul_i32 s6, s35, 4736
    s_add_u32 s7, s6, 147456
    s_cmp_eq_u32 s35, 3
    s_cselect_b32 s7, 18944, s7
    s_waitcnt vmcnt(7)
    s_barrier
    s_waitcnt lgkmcnt(8)
    v_mfma_f32_32x32x16_bf16 v[92:107], v[72:75], a[28:31], v[92:107]
    ds_read_b128 a[32:35], v30 offset:0
    ds_read_b64_tr_b16 v[52:53], v23 offset:0
    ds_read_b64_tr_b16 v[54:55], v23 offset:1280
    buffer_load_dwordx4 v13, s[12:15], s59 offen offset:3072 lds
    s_waitcnt lgkmcnt(9)
    v_mfma_f32_32x32x16_bf16 v[108:123], v[76:79], a[28:31], v[108:123]
    ds_read_b64_tr_b16 v[56:57], v23 offset:64
    ds_read_b64_tr_b16 v[58:59], v23 offset:1344
    s_add_u32 m0, s61, 114688
    s_nop 0
    buffer_load_dwordx4 v14, s[12:15], s59 offen lds
    s_add_u32 s58, s70, s76
    s_add_u32 s58, s58, 1
    s_sub_u32 s67, s58, 9
    s_cmp_ge_u32 s58, 9
    s_cselect_b32 s58, s67, s58
    s_add_u32 s76, s76, 1
    s_and_b32 s76, s76, 7
    s_mul_i32 s59, s58, 221184
    s_lshl_b32 s60, s58, 7
    s_waitcnt lgkmcnt(9)
    v_mfma_f32_32x32x16_bf16 v[124:139], a[28:31], v[80:83], v[124:139]
    ds_read_b64_tr_b16 v[60:61], v23 offset:144
    ds_read_b64_tr_b16 v[62:63], v23 offset:1424
    s_lshr_b32 s63, s2, 3
    s_min_u32 s64, s35, 2
    s_mul_i32 s64, s64, 54
    s_mul_i32 s63, s63, 162
    s_add_u32 s64, s64, s63
    v_min_u32 v51, 53, v1
    v_add_u32 v51, s64, v51
    v_lshlrev_b32 v51, 7, v51
    buffer_load_dword v255, v51, s[16:19], 0 offen
    s_waitcnt lgkmcnt(9)
    v_mfma_f32_32x32x16_bf16 v[140:155], a[28:31], v[84:87], v[140:155]
    ds_read_b64_tr_b16 v[64:65], v23 offset:208
    ds_read_b64_tr_b16 v[66:67], v23 offset:1488
    v_mul_u32_u24 v3, 148, v2
    v_lshl_add_u32 v3, v5, 3, v3
    v_add_u32 v35, s7, v3
    s_add_u32 s6, s6, 0
    v_add_u32 v36, s6, v3
    s_waitcnt lgkmcnt(9)
    v_mfma_f32_32x32x16_bf16 v[156:171], v[88:91], a[28:31], v[156:171]
    ds_read_b64_tr_b16 v[68:69], v25 offset:0
    ds_read_b64_tr_b16 v[70:71], v25 offset:1280
    s_lshl_b32 s61, s35, 12
    s_add_u32 m0, s61, 20480
    s_nop 0
    buffer_load_dwordx4 v15, s[8:11], s60 offen offset:0 lds
    s_waitcnt lgkmcnt(8)
    v_mfma_f32_32x32x16_bf16 v[92:107], v[52:55], a[32:35], v[92:107]
    ds_read_b128 a[36:39], v31 offset:0
    ds_read_b64_tr_b16 v[72:73], v23 offset:5120
    ds_read_b64_tr_b16 v[74:75], v23 offset:6400
    s_mul_i32 s6, s35, 4736
    s_add_u32 s6, s6, 0
    v_mul_u32_u24 v3, 1184, v5
    v_lshl_add_u32 v3, v2, 4, v3
    v_add_u32 v37, s6, v3
    s_waitcnt lgkmcnt(9)
    v_mfma_f32_32x32x16_bf16 v[108:123], v[56:59], a[32:35], v[108:123]
    ds_read_b64_tr_b16 v[76:77], v23 offset:5184
    ds_read_b64_tr_b16 v[78:79], v23 offset:6464
    buffer_load_dwordx4 v16, s[8:11], s60 offen offset:1024 lds
    s_waitcnt lgkmcnt(9)
    v_mfma_f32_32x32x16_bf16 v[124:139], a[32:35], v[60:63], v[124:139]
    ds_read_b64_tr_b16 v[80:81], v23 offset:5264
    ds_read_b64_tr_b16 v[82:83], v23 offset:6544
    v_bfe_u32 v3, v1, 2, 1
    v_mul_u32_u24 v3, 2368, v3
    v_bfe_u32 v4, v1, 1, 1
    v_mul_u32_u24 v4, 1184, v4
    v_add_u32 v3, v3, v4
    s_waitcnt lgkmcnt(9)
    v_mfma_f32_32x32x16_bf16 v[140:155], a[32:35], v[64:67], v[140:155]
    ds_read_b64_tr_b16 v[84:85], v23 offset:5328
    ds_read_b64_tr_b16 v[86:87], v23 offset:6608
    buffer_load_dwordx4 v17, s[8:11], s60 offen offset:2048 lds
    s_waitcnt lgkmcnt(9)
    v_mfma_f32_32x32x16_bf16 v[156:171], v[68:71], a[32:35], v[156:171]
    ds_read_b64_tr_b16 v[88:89], v25 offset:5120
    ds_read_b64_tr_b16 v[90:91], v25 offset:6400
    v_and_b32 v4, 1, v1
    v_lshl_add_u32 v3, v4, 4, v3
    v_add_u32 v3, 1152, v3
    v_add_u32 v42, s6, v3
    v_lshrrev_b32 v3, 4, v2
    s_waitcnt lgkmcnt(8)
    v_mfma_f32_32x32x16_bf16 v[92:107], v[72:75], a[36:39], v[92:107]
    ds_read_b128 a[40:43], v32 offset:0
    ds_read_b64_tr_b16 v[52:53], v23 offset:10240
    ds_read_b64_tr_b16 v[54:55], v23 offset:11520
    buffer_load_dwordx4 v18, s[8:11], s60 offen offset:3072 lds
    s_waitcnt lgkmcnt(9)
    v_mfma_f32_32x32x16_bf16 v[108:123], v[76:79], a[36:39], v[108:123]
    ds_read_b64_tr_b16 v[56:57], v23 offset:10304
    ds_read_b64_tr_b16 v[58:59], v23 offset:11584
    v_mul_u32_u24 v3, 2368, v3
    v_bfe_u32 v4, v2, 2, 1
    v_mul_u32_u24 v4, 1184, v4
    v_add_u32 v3, v3, v4
    v_and_b32 v4, 3, v2
    s_waitcnt lgkmcnt(9)
    v_mfma_f32_32x32x16_bf16 v[124:139], a[36:39], v[80:83], v[124:139]
    ds_read_b64_tr_b16 v[60:61], v23 offset:10384
    ds_read_b64_tr_b16 v[62:63], v23 offset:11664
    s_mul_i32 s61, s35, 5120
    s_add_u32 m0, s61, 0
    s_nop 0
    buffer_load_dwordx4 v10, s[12:15], s59 offen offset:0 lds
    s_waitcnt lgkmcnt(9)
    v_mfma_f32_32x32x16_bf16 v[140:155], a[36:39], v[84:87], v[140:155]
    ds_read_b64_tr_b16 v[64:65], v23 offset:10448
    ds_read_b64_tr_b16 v[66:67], v23 offset:11728
    v_bfe_u32 v6, v2, 3, 1
    v_lshl_add_u32 v4, v6, 2, v4
    v_lshl_add_u32 v3, v4, 1, v3
    v_lshl_add_u32 v3, v5, 6, v3
    v_add_u32 v3, 1024, v3
    s_waitcnt lgkmcnt(9)
    v_mfma_f32_32x32x16_bf16 v[156:171], v[88:91], a[36:39], v[156:171]
    ds_read_b64_tr_b16 v[68:69], v25 offset:10240
    ds_read_b64_tr_b16 v[70:71], v25 offset:11520
    buffer_load_dwordx4 v11, s[12:15], s59 offen offset:1024 lds
    s_waitcnt lgkmcnt(8)
    v_mfma_f32_32x32x16_bf16 v[92:107], v[52:55], a[40:43], v[92:107]
    ds_read_b128 a[44:47], v33 offset:0
    ds_read_b64_tr_b16 v[72:73], v23 offset:15360
    ds_read_b64_tr_b16 v[74:75], v23 offset:16640
    v_add_u32 v38, s6, v3
    s_mul_i32 s6, s35, 36
    v_mul_u32_u24 v3, 148, v2
    v_add_u32 v3, s6, v3
    v_lshl_add_u32 v39, v5, 4, v3
    s_waitcnt lgkmcnt(9)
    v_mfma_f32_32x32x16_bf16 v[108:123], v[56:59], a[40:43], v[108:123]
    ds_read_b64_tr_b16 v[76:77], v23 offset:15424
    ds_read_b64_tr_b16 v[78:79], v23 offset:16704
    buffer_load_dwordx4 v12, s[12:15], s59 offen offset:2048 lds
    s_waitcnt lgkmcnt(9)
    v_mfma_f32_32x32x16_bf16 v[124:139], a[40:43], v[60:63], v[124:139]
    ds_read_b64_tr_b16 v[80:81], v23 offset:15504
    ds_read_b64_tr_b16 v[82:83], v23 offset:16784
    v_add_u32 v40, 32, v3
    s_mul_i32 s6, s35, 18
    v_add_u32 v3, s6, v2
    v_and_b32 v4, 27, v2
    v_cmp_eq_u32 vcc, 18, v4
    s_waitcnt lgkmcnt(9)
    v_mfma_f32_32x32x16_bf16 v[140:155], a[40:43], v[64:67], v[140:155]
    ds_read_b64_tr_b16 v[84:85], v23 offset:15568
    ds_read_b64_tr_b16 v[86:87], v23 offset:16848
    buffer_load_dwordx4 v13, s[12:15], s59 offen offset:3072 lds
    s_waitcnt lgkmcnt(9)
    v_mfma_f32_32x32x16_bf16 v[156:171], v[68:71], a[40:43], v[156:171]
    ds_read_b64_tr_b16 v[88:89], v25 offset:15360
    ds_read_b64_tr_b16 v[90:91], v25 offset:16640
    v_mov_b32 v4, 73
    v_mov_b32 v6, 72
    v_cndmask_b32 v4, v4, v6, vcc
    v_cmp_gt_u32 vcc, 18, v2
    s_nop 1
    s_waitcnt vmcnt(9)
    s_barrier
    s_waitcnt lgkmcnt(8)
    v_mfma_f32_32x32x16_bf16 v[92:107], v[72:75], a[44:47], v[92:107]
    ds_read_b128 a[48:51], v30 offset:36864
    ds_read_b64_tr_b16 v[52:53], v23 offset:36864
    ds_read_b64_tr_b16 v[54:55], v23 offset:38144
    s_add_u32 m0, s61, 4096
    s_nop 0
    buffer_load_dwordx4 v14, s[12:15], s59 offen lds
    s_add_u32 s58, s70, s76
    s_add_u32 s58, s58, 1
    s_sub_u32 s67, s58, 9
    s_cmp_ge_u32 s58, 9
    s_cselect_b32 s58, s67, s58
    s_add_u32 s76, s76, 1
    s_and_b32 s76, s76, 7
    s_mul_i32 s59, s58, 221184
    s_lshl_b32 s60, s58, 7
    s_waitcnt lgkmcnt(9)
    v_mfma_f32_32x32x16_bf16 v[108:123], v[76:79], a[44:47], v[108:123]
    ds_read_b64_tr_b16 v[56:57], v23 offset:36928
    ds_read_b64_tr_b16 v[58:59], v23 offset:38208
    v_cndmask_b32 v3, v4, v3, vcc
    v_lshlrev_b32 v3, 4, v3
    v_mul_u32_u24 v4, 1184, v5
    v_add_u32 v41, v3, v4
    v_lshlrev_b32 v44, 4, v1
    s_waitcnt lgkmcnt(9)
    v_mfma_f32_32x32x16_bf16 v[124:139], a[44:47], v[80:83], v[124:139]
    ds_read_b64_tr_b16 v[60:61], v23 offset:37008
    ds_read_b64_tr_b16 v[62:63], v23 offset:38288
    s_lshl_b32 s61, s35, 12
    s_add_u32 m0, s61, 57344
    s_nop 0
    buffer_load_dwordx4 v15, s[8:11], s60 offen offset:0 lds
    s_waitcnt lgkmcnt(9)
    v_mfma_f32_32x32x16_bf16 v[140:155], a[44:47], v[84:87], v[140:155]
    ds_read_b64_tr_b16 v[64:65], v23 offset:37072
    ds_read_b64_tr_b16 v[66:67], v23 offset:38352
    v_lshlrev_b32 v45, 2, v2
    v_add_u32 v45, 1024, v45
    v_mul_u32_u24 v3, 288, v5
    v_lshl_add_u32 v3, v2, 4, v3
    v_add_u32 v46, 1152, v3
    s_waitcnt lgkmcnt(9)
    v_mfma_f32_32x32x16_bf16 v[156:171], v[88:91], a[44:47], v[156:171]
    ds_read_b64_tr_b16 v[68:69], v25 offset:36864
    ds_read_b64_tr_b16 v[70:71], v25 offset:38144
    buffer_load_dwordx4 v16, s[8:11], s60 offen offset:1024 lds
    s_waitcnt lgkmcnt(8)
    v_mfma_f32_32x32x16_bf16 v[92:107], v[52:55], a[48:51], v[92:107]
    ds_read_b128 a[52:55], v31 offset:36864
    ds_read_b64_tr_b16 v[72:73], v23 offset:41984
    ds_read_b64_tr_b16 v[74:75], v23 offset:43264
    s_lshl_b32 s6, s35, 2
    v_lshrrev_b32 v3, 3, v2
    v_mul_u32_u24 v3, 2304, v3
    v_and_b32 v4, 7, v2
    v_lshl_add_u32 v3, v4, 4, v3
    s_waitcnt lgkmcnt(9)
    v_mfma_f32_32x32x16_bf16 v[108:123], v[56:59], a[48:51], v[108:123]
    ds_read_b64_tr_b16 v[76:77], v23 offset:42048
    ds_read_b64_tr_b16 v[78:79], v23 offset:43328
    buffer_load_dwordx4 v17, s[8:11], s60 offen offset:2048 lds
    s_waitcnt lgkmcnt(9)
    v_mfma_f32_32x32x16_bf16 v[124:139], a[48:51], v[60:63], v[124:139]
    ds_read_b64_tr_b16 v[80:81], v23 offset:42128
    ds_read_b64_tr_b16 v[82:83], v23 offset:43408
    v_add_u32 v47, s6, v3
    v_and_b32 v3, 27, v2
    v_cmp_eq_u32 vcc, 18, v3
    v_mov_b32 v4, 0x3f803f80
    s_nop 0
    s_waitcnt lgkmcnt(9)
    v_mfma_f32_32x32x16_bf16 v[140:155], a[48:51], v[64:67], v[140:155]
    ds_read_b64_tr_b16 v[84:85], v23 offset:42192
    ds_read_b64_tr_b16 v[86:87], v23 offset:43472
    buffer_load_dwordx4 v18, s[8:11], s60 offen offset:3072 lds
    s_waitcnt lgkmcnt(9)
    v_mfma_f32_32x32x16_bf16 v[156:171], v[68:71], a[48:51], v[156:171]
    ds_read_b64_tr_b16 v[88:89], v25 offset:41984
    ds_read_b64_tr_b16 v[90:91], v25 offset:43264
    v_cndmask_b32 v50, 0, v4, vcc
    s_lshl_b32 s6, s32, 3
    s_add_u32 s6, s6, s34
    s_lshl_b32 s6, s6, 4
    s_add_u32 s6, s6, s33
    s_waitcnt lgkmcnt(8)
    v_mfma_f32_32x32x16_bf16 v[92:107], v[72:75], a[52:55], v[92:107]
    ds_read_b128 a[56:59], v32 offset:36864
    ds_read_b64_tr_b16 v[52:53], v23 offset:47104
    ds_read_b64_tr_b16 v[54:55], v23 offset:48384
    s_mul_i32 s61, s35, 5120
    s_add_u32 m0, s61, 36864
    s_nop 0
    buffer_load_dwordx4 v10, s[12:15], s59 offen offset:0 lds
    s_waitcnt lgkmcnt(9)
    v_mfma_f32_32x32x16_bf16 v[108:123], v[76:79], a[52:55], v[108:123]
    ds_read_b64_tr_b16 v[56:57], v23 offset:47168
    ds_read_b64_tr_b16 v[58:59], v23 offset:48448
    s_mul_i32 s62, s6, 36864
    s_mul_i32 s7, s35, 2304
    s_add_u32 s62, s62, s7
    s_sub_u32 s71, s62, 36864
    s_sub_u32 s72, s62, 73728
    s_waitcnt lgkmcnt(9)
    v_mfma_f32_32x32x16_bf16 v[124:139], a[52:55], v[80:83], v[124:139]
    ds_read_b64_tr_b16 v[60:61], v23 offset:47248
    ds_read_b64_tr_b16 v[62:63], v23 offset:48528
    buffer_load_dwordx4 v11, s[12:15], s59 offen offset:1024 lds
    s_waitcnt lgkmcnt(9)
    v_mfma_f32_32x32x16_bf16 v[140:155], a[52:55], v[84:87], v[140:155]
    ds_read_b64_tr_b16 v[64:65], v23 offset:47312
    ds_read_b64_tr_b16 v[66:67], v23 offset:48592
    s_cmp_ge_u32 s33, 1
    s_cselect_b32 s71, s71, 0x70000000
    s_cmp_ge_u32 s33, 2
    s_cselect_b32 s72, s72, 0x70000000
    s_lshl_b32 s6, s6, 2
    s_waitcnt lgkmcnt(9)
    v_mfma_f32_32x32x16_bf16 v[156:171], v[88:91], a[52:55], v[156:171]
    ds_read_b64_tr_b16 v[68:69], v25 offset:47104
    ds_read_b64_tr_b16 v[70:71], v25 offset:48384
    buffer_load_dwordx4 v12, s[12:15], s59 offen offset:2048 lds
    s_waitcnt lgkmcnt(8)
    v_mfma_f32_32x32x16_bf16 v[92:107], v[52:55], a[56:59], v[92:107]
    ds_read_b128 a[60:63], v33 offset:36864
    ds_read_b64_tr_b16 v[72:73], v23 offset:52224
    ds_read_b64_tr_b16 v[74:75], v23 offset:53504
    s_add_u32 s6, s6, s35
    s_lshl_b32 s6, s6, 7
    s_add_u32 s66, s6, 25165824
    s_cmp_ge_u32 s33, 1
    s_cselect_b32 s6, -1, 0
    s_waitcnt lgkmcnt(9)
    v_mfma_f32_32x32x16_bf16 v[108:123], v[56:59], a[56:59], v[108:123]
    ds_read_b64_tr_b16 v[76:77], v23 offset:52288
    ds_read_b64_tr_b16 v[78:79], v23 offset:53568
    buffer_load_dwordx4 v13, s[12:15], s59 offen offset:3072 lds
    s_waitcnt lgkmcnt(9)
    v_mfma_f32_32x32x16_bf16 v[124:139], a[56:59], v[60:63], v[124:139]
    ds_read_b64_tr_b16 v[80:81], v23 offset:52368
    ds_read_b64_tr_b16 v[82:83], v23 offset:53648
    s_cmp_ge_u32 s33, 2
    s_cselect_b32 s7, -1, 0
    v_and_b32 v2, s6, v50
    v_and_b32 v3, s7, v50
    v_mov_b32 v4, 0x3f803f80
    s_waitcnt lgkmcnt(9)
    v_mfma_f32_32x32x16_bf16 v[140:155], a[56:59], v[64:67], v[140:155]
    ds_read_b64_tr_b16 v[84:85], v23 offset:52432
    ds_read_b64_tr_b16 v[86:87], v23 offset:53712
    s_add_u32 m0, s61, 40960
    s_nop 0
    buffer_load_dwordx4 v14, s[12:15], s59 offen lds
    s_add_u32 s58, s70, s76
    s_add_u32 s58, s58, 1
    s_sub_u32 s67, s58, 9
    s_cmp_ge_u32 s58, 9
    s_cselect_b32 s58, s67, s58
    s_add_u32 s76, s76, 1
    s_and_b32 s76, s76, 7
    s_mul_i32 s59, s58, 221184
    s_lshl_b32 s60, s58, 7
    s_waitcnt lgkmcnt(9)
    v_mfma_f32_32x32x16_bf16 v[156:171], v[68:71], a[56:59], v[156:171]
    ds_read_b64_tr_b16 v[88:89], v25 offset:52224
    ds_read_b64_tr_b16 v[90:91], v25 offset:53504
    v_and_b32 v6, s7, v4
    v_and_b32 v4, s6, v4
    v_accvgpr_write_b32 a149, v6
    v_accvgpr_write_b32 a150, v3
    v_accvgpr_write_b32 a151, v3
    s_waitcnt vmcnt(9)
    s_barrier
    s_waitcnt lgkmcnt(8)
    v_mfma_f32_32x32x16_bf16 v[92:107], v[72:75], a[60:63], v[92:107]
    ds_read_b128 a[64:67], v26 offset:0
    ds_read_b64_tr_b16 v[52:53], v22 offset:0
    ds_read_b64_tr_b16 v[54:55], v22 offset:1280
    s_lshl_b32 s61, s35, 12
    s_add_u32 m0, s61, 94208
    s_nop 0
    buffer_load_dwordx4 v15, s[8:11], s60 offen offset:0 lds
    s_waitcnt lgkmcnt(9)
    v_mfma_f32_32x32x16_bf16 v[108:123], v[76:79], a[60:63], v[108:123]
    ds_read_b64_tr_b16 v[56:57], v22 offset:64
    ds_read_b64_tr_b16 v[58:59], v22 offset:1344
    v_accvgpr_write_b32 a152, v3
    v_accvgpr_write_b32 a153, v3
    v_accvgpr_write_b32 a154, v3
    v_accvgpr_write_b32 a155, v3
    v_accvgpr_write_b32 a156, v3
    s_waitcnt lgkmcnt(9)
    v_mfma_f32_32x32x16_bf16 v[124:139], a[60:63], v[80:83], v[124:139]
    ds_read_b64_tr_b16 v[60:61], v22 offset:144
    ds_read_b64_tr_b16 v[62:63], v22 offset:1424
    buffer_load_dwordx4 v16, s[8:11], s60 offen offset:1024 lds
    s_waitcnt lgkmcnt(9)
    v_mfma_f32_32x32x16_bf16 v[140:155], a[60:63], v[84:87], v[140:155]
    ds_read_b64_tr_b16 v[64:65], v22 offset:208
    ds_read_b64_tr_b16 v[66:67], v22 offset:1488
    v_accvgpr_write_b32 a157, v3
    v_accvgpr_write_b32 a163, v6
    v_accvgpr_write_b32 a164, v3
    v_accvgpr_write_b32 a165, v3
    v_accvgpr_write_b32 a166, v3
    s_waitcnt lgkmcnt(9)
    v_mfma_f32_32x32x16_bf16 v[156:171], v[88:91], a[60:63], v[156:171]
    ds_read_b64_tr_b16 v[68:69], v24 offset:0
    ds_read_b64_tr_b16 v[70:71], v24 offset:1280
    buffer_load_dwordx4 v17, s[8:11], s60 offen offset:2048 lds
    s_waitcnt lgkmcnt(8)
    v_mfma_f32_32x32x16_bf16 v[92:107], v[52:55], a[64:67], v[92:107]
    ds_read_b128 a[68:71], v27 offset:0
    ds_read_b64_tr_b16 v[72:73], v22 offset:5120
    ds_read_b64_tr_b16 v[74:75], v22 offset:6400
    v_accvgpr_write_b32 a167, v3
    v_accvgpr_write_b32 a168, v3
    v_accvgpr_write_b32 a169, v3
    v_accvgpr_write_b32 a170, v3
    v_accvgpr_write_b32 a171, v3
    s_waitcnt lgkmcnt(9)
    v_mfma_f32_32x32x16_bf16 v[108:123], v[56:59], a[64:67], v[108:123]
    ds_read_b64_tr_b16 v[76:77], v22 offset:5184
    ds_read_b64_tr_b16 v[78:79], v22 offset:6464
    buffer_load_dwordx4 v18, s[8:11], s60 offen offset:3072 lds
    s_waitcnt lgkmcnt(9)
    v_mfma_f32_32x32x16_bf16 v[124:139], a[64:67], v[60:63], v[124:139]
    ds_read_b64_tr_b16 v[80:81], v22 offset:5264
    ds_read_b64_tr_b16 v[82:83], v22 offset:6544
    v_accvgpr_write_b32 a177, v6
    v_accvgpr_write_b32 a178, v3
    v_accvgpr_write_b32 a179, v3
    v_accvgpr_write_b32 a180, v3
    v_accvgpr_write_b32 a181, v3
    s_waitcnt lgkmcnt(9)
    v_mfma_f32_32x32x16_bf16 v[140:155], a[64:67], v[64:67], v[140:155]
    ds_read_b64_tr_b16 v[84:85], v22 offset:5328
    ds_read_b64_tr_b16 v[86:87], v22 offset:6608
    s_mul_i32 s61, s35, 5120
    s_add_u32 m0, s61, 73728
    s_nop 0
    buffer_load_dwordx4 v10, s[12:15], s59 offen offset:0 lds
    s_waitcnt lgkmcnt(9)
    v_mfma_f32_32x32x16_bf16 v[156:171], v[68:71], a[64:67], v[156:171]
    ds_read_b64_tr_b16 v[88:89], v24 offset:5120
    ds_read_b64_tr_b16 v[90:91], v24 offset:6400
    v_accvgpr_write_b32 a182, v3
    v_accvgpr_write_b32 a183, v3
    v_accvgpr_write_b32 a184, v3
    v_accvgpr_write_b32 a185, v3
    v_accvgpr_write_b32 a191, v6
    s_waitcnt lgkmcnt(8)
    v_mfma_f32_32x32x16_bf16 v[92:107], v[72:75], a[68:71], v[92:107]
    ds_read_b128 a[72:75], v28 offset:0
    ds_read_b64_tr_b16 v[52:53], v22 offset:10240
    ds_read_b64_tr_b16 v[54:55], v22 offset:11520
    buffer_load_dwordx4 v11, s[12:15], s59 offen offset:1024 lds
    s_waitcnt lgkmcnt(9)
    v_mfma_f32_32x32x16_bf16 v[108:123], v[76:79], a[68:71], v[108:123]
    ds_read_b64_tr_b16 v[56:57], v22 offset:10304
    ds_read_b64_tr_b16 v[58:59], v22 offset:11584
    v_accvgpr_write_b32 a192, v3
    v_accvgpr_write_b32 a193, v3
    v_accvgpr_write_b32 a194, v3
    v_accvgpr_write_b32 a195, v3
    v_accvgpr_write_b32 a196, v3
    s_waitcnt lgkmcnt(9)
    v_mfma_f32_32x32x16_bf16 v[124:139], a[68:71], v[80:83], v[124:139]
    ds_read_b64_tr_b16 v[60:61], v22 offset:10384
    ds_read_b64_tr_b16 v[62:63], v22 offset:11664
    buffer_load_dwordx4 v12, s[12:15], s59 offen offset:2048 lds
    s_waitcnt lgkmcnt(9)
    v_mfma_f32_32x32x16_bf16 v[140:155], a[68:71], v[84:87], v[140:155]
    ds_read_b64_tr_b16 v[64:65], v22 offset:10448
    ds_read_b64_tr_b16 v[66:67], v22 offset:11728
    v_accvgpr_write_b32 a197, v3
    v_accvgpr_write_b32 a198, v3
    v_accvgpr_write_b32 a199, v3
    v_accvgpr_write_b32 a205, v4
    v_accvgpr_write_b32 a206, v2
    s_waitcnt lgkmcnt(9)
    v_mfma_f32_32x32x16_bf16 v[156:171], v[88:91], a[68:71], v[156:171]
    ds_read_b64_tr_b16 v[68:69], v24 offset:10240
    ds_read_b64_tr_b16 v[70:71], v24 offset:11520
    buffer_load_dwordx4 v13, s[12:15], s59 offen offset:3072 lds
    s_waitcnt lgkmcnt(8)
    v_mfma_f32_32x32x16_bf16 v[92:107], v[52:55], a[72:75], v[92:107]
    ds_read_b128 a[76:79], v29 offset:0
    ds_read_b64_tr_b16 v[72:73], v22 offset:15360
    ds_read_b64_tr_b16 v[74:75], v22 offset:16640
    v_accvgpr_write_b32 a207, v2
    v_accvgpr_write_b32 a208, v2
    v_accvgpr_write_b32 a209, v2
    v_accvgpr_write_b32 a210, v2
    v_accvgpr_write_b32 a211, v2
    s_waitcnt lgkmcnt(9)
    v_mfma_f32_32x32x16_bf16 v[108:123], v[56:59], a[72:75], v[108:123]
    ds_read_b64_tr_b16 v[76:77], v22 offset:15424
    ds_read_b64_tr_b16 v[78:79], v22 offset:16704
    s_add_u32 m0, s61, 77824
    s_nop 0
    buffer_load_dwordx4 v14, s[12:15], s59 offen lds
    s_add_u32 s58, s70, s76
    s_add_u32 s58, s58, 1
    s_sub_u32 s67, s58, 9
    s_cmp_ge_u32 s58, 9
    s_cselect_b32 s58, s67, s58
    s_add_u32 s76, s76, 1
    s_and_b32 s76, s76, 7
    s_mul_i32 s59, s58, 221184
    s_lshl_b32 s60, s58, 7
    s_waitcnt lgkmcnt(9)
    v_mfma_f32_32x32x16_bf16 v[124:139], a[72:75], v[60:63], v[124:139]
    ds_read_b64_tr_b16 v[80:81], v22 offset:15504
    ds_read_b64_tr_b16 v[82:83], v22 offset:16784
    v_accvgpr_write_b32 a212, v2
    v_accvgpr_write_b32 a213, v2
    v_accvgpr_write_b32 a219, v4
    v_accvgpr_write_b32 a220, v2
    v_accvgpr_write_b32 a221, v2
    s_waitcnt lgkmcnt(9)
    v_mfma_f32_32x32x16_bf16 v[140:155], a[72:75], v[64:67], v[140:155]
    ds_read_b64_tr_b16 v[84:85], v22 offset:15568
    ds_read_b64_tr_b16 v[86:87], v22 offset:16848
    v_accvgpr_write_b32 a222, v2
    v_accvgpr_write_b32 a223, v2
    v_accvgpr_write_b32 a224, v2
    v_accvgpr_write_b32 a225, v2
    v_accvgpr_write_b32 a226, v2
    s_waitcnt lgkmcnt(9)
    v_mfma_f32_32x32x16_bf16 v[156:171], v[68:71], a[72:75], v[156:171]
    ds_read_b64_tr_b16 v[88:89], v24 offset:15360
    ds_read_b64_tr_b16 v[90:91], v24 offset:16640
    v_accvgpr_write_b32 a227, v2
    v_accvgpr_write_b32 a233, v4
    v_accvgpr_write_b32 a234, v2
    v_accvgpr_write_b32 a235, v2
    v_accvgpr_write_b32 a236, v2
    s_waitcnt vmcnt(9)
    s_barrier
    s_waitcnt lgkmcnt(8)
    v_mfma_f32_32x32x16_bf16 v[92:107], v[72:75], a[76:79], v[92:107]
    ds_read_b128 a[80:83], v26 offset:36864
    ds_read_b64_tr_b16 v[52:53], v22 offset:36864
    ds_read_b64_tr_b16 v[54:55], v22 offset:38144
    s_lshl_b32 s61, s35, 12
    s_add_u32 m0, s61, 131072
    s_nop 0
    buffer_load_dwordx4 v15, s[8:11], s60 offen offset:0 lds
    s_waitcnt lgkmcnt(9)
    v_mfma_f32_32x32x16_bf16 v[108:123], v[76:79], a[76:79], v[108:123]
    ds_read_b64_tr_b16 v[56:57], v22 offset:36928
    ds_read_b64_tr_b16 v[58:59], v22 offset:38208
    v_accvgpr_write_b32 a237, v2
    v_accvgpr_write_b32 a238, v2
    v_accvgpr_write_b32 a239, v2
    v_accvgpr_write_b32 a240, v2
    v_accvgpr_write_b32 a241, v2
    s_waitcnt lgkmcnt(9)
    v_mfma_f32_32x32x16_bf16 v[124:139], a[76:79], v[80:83], v[124:139]
    ds_read_b64_tr_b16 v[60:61], v22 offset:37008
    ds_read_b64_tr_b16 v[62:63], v22 offset:38288
    buffer_load_dwordx4 v16, s[8:11], s60 offen offset:1024 lds
    s_waitcnt lgkmcnt(9)
    v_mfma_f32_32x32x16_bf16 v[140:155], a[76:79], v[84:87], v[140:155]
    ds_read_b64_tr_b16 v[64:65], v22 offset:37072
    ds_read_b64_tr_b16 v[66:67], v22 offset:38352
    v_accvgpr_write_b32 a247, v4
    v_accvgpr_write_b32 a248, v2
    v_accvgpr_write_b32 a249, v2
    v_accvgpr_write_b32 a250, v2
    v_accvgpr_write_b32 a251, v2
    s_waitcnt lgkmcnt(9)
    v_mfma_f32_32x32x16_bf16 v[156:171], v[88:91], a[76:79], v[156:171]
    ds_read_b64_tr_b16 v[68:69], v24 offset:36864
    ds_read_b64_tr_b16 v[70:71], v24 offset:38144
    buffer_load_dwordx4 v17, s[8:11], s60 offen offset:2048 lds
    s_waitcnt lgkmcnt(8)
    v_mfma_f32_32x32x16_bf16 v[92:107], v[52:55], a[80:83], v[92:107]
    ds_read_b128 a[84:87], v27 offset:36864
    ds_read_b64_tr_b16 v[72:73], v22 offset:41984
    ds_read_b64_tr_b16 v[74:75], v22 offset:43264
    v_accvgpr_write_b32 a252, v2
    v_accvgpr_write_b32 a253, v2
    v_accvgpr_write_b32 a254, v2
    v_accvgpr_write_b32 a255, v2
    v_and_b32 v2, 31, v1
    s_waitcnt lgkmcnt(9)
    v_mfma_f32_32x32x16_bf16 v[108:123], v[56:59], a[80:83], v[108:123]
    ds_read_b64_tr_b16 v[76:77], v22 offset:42048
    ds_read_b64_tr_b16 v[78:79], v22 offset:43328
    buffer_load_dwordx4 v18, s[8:11], s60 offen offset:3072 lds
    s_waitcnt lgkmcnt(9)
    v_mfma_f32_32x32x16_bf16 v[124:139], a[80:83], v[60:63], v[124:139]
    ds_read_b64_tr_b16 v[80:81], v22 offset:42128
    ds_read_b64_tr_b16 v[82:83], v22 offset:43408
    v_lshlrev_b32 v3, 2, v5
    v_sub_u32 v2, v2, v3
    v_mov_b32 v6, 0xffff
    v_mov_b32 v7, 0xffff0000
    v_cmp_le_i32 vcc, 0, v2
    s_waitcnt lgkmcnt(9)
    v_mfma_f32_32x32x16_bf16 v[140:155], a[80:83], v[64:67], v[140:155]
    ds_read_b64_tr_b16 v[84:85], v22 offset:42192
    ds_read_b64_tr_b16 v[86:87], v22 offset:43472
    s_mul_i32 s61, s35, 5120
    s_add_u32 m0, s61, 110592
    s_nop 0
    buffer_load_dwordx4 v10, s[12:15], s59 offen offset:0 lds
    s_waitcnt lgkmcnt(9)
    v_mfma_f32_32x32x16_bf16 v[156:171], v[68:71], a[80:83], v[156:171]
    ds_read_b64_tr_b16 v[88:89], v24 offset:41984
    ds_read_b64_tr_b16 v[90:91], v24 offset:43264
    v_cmp_le_i32 s[4:5], 1, v2
    s_nop 0
    v_cndmask_b32 v3, 0, v6, vcc
    v_cndmask_b32 v4, 0, v7, s[4:5]
    v_or_b32 v236, v3, v4
    s_waitcnt lgkmcnt(8)
    v_mfma_f32_32x32x16_bf16 v[92:107], v[72:75], a[84:87], v[92:107]
    ds_read_b128 a[88:91], v28 offset:36864
    ds_read_b64_tr_b16 v[52:53], v22 offset:47104
    ds_read_b64_tr_b16 v[54:55], v22 offset:48384
    buffer_load_dwordx4 v11, s[12:15], s59 offen offset:1024 lds
    s_waitcnt lgkmcnt(9)
    v_mfma_f32_32x32x16_bf16 v[108:123], v[76:79], a[84:87], v[108:123]
    ds_read_b64_tr_b16 v[56:57], v22 offset:47168
    ds_read_b64_tr_b16 v[58:59], v22 offset:48448
    v_not_b32 v244, v236
    v_cmp_le_i32 vcc, 2, v2
    v_cmp_le_i32 s[4:5], 3, v2
    s_nop 0
    v_cndmask_b32 v3, 0, v6, vcc
    s_waitcnt lgkmcnt(9)
    v_mfma_f32_32x32x16_bf16 v[124:139], a[84:87], v[80:83], v[124:139]
    ds_read_b64_tr_b16 v[60:61], v22 offset:47248
    ds_read_b64_tr_b16 v[62:63], v22 offset:48528
    buffer_load_dwordx4 v12, s[12:15], s59 offen offset:2048 lds
    s_waitcnt lgkmcnt(9)
    v_mfma_f32_32x32x16_bf16 v[140:155], a[84:87], v[84:87], v[140:155]
    ds_read_b64_tr_b16 v[64:65], v22 offset:47312
    ds_read_b64_tr_b16 v[66:67], v22 offset:48592
    v_cndmask_b32 v4, 0, v7, s[4:5]
    v_or_b32 v237, v3, v4
    v_not_b32 v245, v237
    v_cmp_le_i32 vcc, 8, v2
    v_cmp_le_i32 s[4:5], 9, v2
    s_waitcnt lgkmcnt(9)
    v_mfma_f32_32x32x16_bf16 v[156:171], v[88:91], a[84:87], v[156:171]
    ds_read_b64_tr_b16 v[68:69], v24 offset:47104
    ds_read_b64_tr_b16 v[70:71], v24 offset:48384
    buffer_load_dwordx4 v13, s[12:15], s59 offen offset:3072 lds
    s_waitcnt lgkmcnt(8)
    v_mfma_f32_32x32x16_bf16 v[92:107], v[52:55], a[88:91], v[92:107]
    ds_read_b128 a[92:95], v29 offset:36864
    ds_read_b64_tr_b16 v[72:73], v22 offset:52224
    ds_read_b64_tr_b16 v[74:75], v22 offset:53504
    s_nop 0
    v_cndmask_b32 v3, 0, v6, vcc
    v_cndmask_b32 v4, 0, v7, s[4:5]
    v_or_b32 v238, v3, v4
    v_not_b32 v246, v238
    s_waitcnt lgkmcnt(9)
    v_mfma_f32_32x32x16_bf16 v[108:123], v[56:59], a[88:91], v[108:123]
    ds_read_b64_tr_b16 v[76:77], v22 offset:52288
    ds_read_b64_tr_b16 v[78:79], v22 offset:53568
    s_add_u32 m0, s61, 114688
    s_nop 0
    buffer_load_dwordx4 v14, s[12:15], s59 offen lds
    s_add_u32 s58, s70, s76
    s_add_u32 s58, s58, 1
    s_sub_u32 s67, s58, 9
    s_cmp_ge_u32 s58, 9
    s_cselect_b32 s58, s67, s58
    s_add_u32 s76, s76, 1
    s_and_b32 s76, s76, 7
    s_mul_i32 s59, s58, 221184
    s_lshl_b32 s60, s58, 7
    s_waitcnt lgkmcnt(9)
    v_mfma_f32_32x32x16_bf16 v[124:139], a[88:91], v[60:63], v[124:139]
    ds_read_b64_tr_b16 v[80:81], v22 offset:52368
    ds_read_b64_tr_b16 v[82:83], v22 offset:53648
    v_cmp_le_i32 vcc, 10, v2
    v_cmp_le_i32 s[4:5], 11, v2
    s_nop 0
    v_cndmask_b32 v3, 0, v6, vcc
    v_cndmask_b32 v4, 0, v7, s[4:5]
    s_waitcnt lgkmcnt(9)
    v_mfma_f32_32x32x16_bf16 v[140:155], a[88:91], v[64:67], v[140:155]
    ds_read_b64_tr_b16 v[84:85], v22 offset:52432
    ds_read_b64_tr_b16 v[86:87], v22 offset:53712
    v_or_b32 v239, v3, v4
    v_not_b32 v247, v239
    v_cmp_le_i32 vcc, 16, v2
    v_cmp_le_i32 s[4:5], 17, v2
    s_nop 0
    s_waitcnt lgkmcnt(9)
    v_mfma_f32_32x32x16_bf16 v[156:171], v[68:71], a[88:91], v[156:171]
    ds_read_b64_tr_b16 v[88:89], v24 offset:52224
    ds_read_b64_tr_b16 v[90:91], v24 offset:53504
    v_cndmask_b32 v3, 0, v6, vcc
    v_cndmask_b32 v4, 0, v7, s[4:5]
    v_or_b32 v240, v3, v4
    v_not_b32 v248, v240
    v_cmp_le_i32 vcc, 18, v2
    s_waitcnt vmcnt(9)
    s_barrier
    s_waitcnt lgkmcnt(8)
    v_mfma_f32_32x32x16_bf16 v[92:107], v[72:75], a[92:95], v[92:107]
    ds_read_b128 a[96:99], v30 offset:0
    ds_read_b64_tr_b16 v[52:53], v23 offset:0
    ds_read_b64_tr_b16 v[54:55], v23 offset:1280
    s_lshl_b32 s61, s35, 12
    s_add_u32 m0, s61, 20480
    s_nop 0
    buffer_load_dwordx4 v15, s[8:11], s60 offen offset:0 lds
    s_waitcnt lgkmcnt(9)
    v_mfma_f32_32x32x16_bf16 v[108:123], v[76:79], a[92:95], v[108:123]
    ds_read_b64_tr_b16 v[56:57], v23 offset:64
    ds_read_b64_tr_b16 v[58:59], v23 offset:1344
    v_cmp_le_i32 s[4:5], 19, v2
    s_nop 0
    v_cndmask_b32 v3, 0, v6, vcc
    v_cndmask_b32 v4, 0, v7, s[4:5]
    v_or_b32 v241, v3, v4
    s_waitcnt lgkmcnt(9)
    v_mfma_f32_32x32x16_bf16 v[124:139], a[92:95], v[80:83], v[124:139]
    ds_read_b64_tr_b16 v[60:61], v23 offset:144
    ds_read_b64_tr_b16 v[62:63], v23 offset:1424
    buffer_load_dwordx4 v16, s[8:11], s60 offen offset:1024 lds
    s_waitcnt lgkmcnt(9)
    v_mfma_f32_32x32x16_bf16 v[140:155], a[92:95], v[84:87], v[140:155]
    ds_read_b64_tr_b16 v[64:65], v23 offset:208
    ds_read_b64_tr_b16 v[66:67], v23 offset:1488
    v_not_b32 v249, v241
    v_cmp_le_i32 vcc, 24, v2
    v_cmp_le_i32 s[4:5], 25, v2
    s_nop 0
    v_cndmask_b32 v3, 0, v6, vcc
    s_waitcnt lgkmcnt(9)
    v_mfma_f32_32x32x16_bf16 v[156:171], v[88:91], a[92:95], v[156:171]
    ds_read_b64_tr_b16 v[68:69], v25 offset:0
    ds_read_b64_tr_b16 v[70:71], v25 offset:1280
    buffer_load_dwordx4 v17, s[8:11], s60 offen offset:2048 lds
    s_waitcnt lgkmcnt(8)
    v_mfma_f32_32x32x16_bf16 v[92:107], v[52:55], a[96:99], v[92:107]
    ds_read_b128 a[100:103], v31 offset:0
    ds_read_b64_tr_b16 v[72:73], v23 offset:5120
    ds_read_b64_tr_b16 v[74:75], v23 offset:6400
    v_cndmask_b32 v4, 0, v7, s[4:5]
    v_or_b32 v242, v3, v4
    v_not_b32 v250, v242
    v_cmp_le_i32 vcc, 26, v2
    v_cmp_le_i32 s[4:5], 27, v2
    s_waitcnt lgkmcnt(9)
    v_mfma_f32_32x32x16_bf16 v[108:123], v[56:59], a[96:99], v[108:123]
    ds_read_b64_tr_b16 v[76:77], v23 offset:5184
    ds_read_b64_tr_b16 v[78:79], v23 offset:6464
    buffer_load_dwordx4 v18, s[8:11], s60 offen offset:3072 lds
    s_waitcnt lgkmcnt(9)
    v_mfma_f32_32x32x16_bf16 v[124:139], a[96:99], v[60:63], v[124:139]
    ds_read_b64_tr_b16 v[80:81], v23 offset:5264
    ds_read_b64_tr_b16 v[82:83], v23 offset:6544
    s_nop 0
    v_cndmask_b32 v3, 0, v6, vcc
    v_cndmask_b32 v4, 0, v7, s[4:5]
    v_or_b32 v243, v3, v4
    v_not_b32 v251, v243
    s_waitcnt lgkmcnt(9)
    v_mfma_f32_32x32x16_bf16 v[140:155], a[96:99], v[64:67], v[140:155]
    ds_read_b64_tr_b16 v[84:85], v23 offset:5328
    ds_read_b64_tr_b16 v[86:87], v23 offset:6608
    s_mul_i32 s61, s35, 5120
    s_add_u32 m0, s61, 0
    s_nop 0
    buffer_load_dwordx4 v10, s[12:15], s59 offen offset:0 lds
    s_waitcnt lgkmcnt(9)
    v_mfma_f32_32x32x16_bf16 v[156:171], v[68:71], a[96:99], v[156:171]
    ds_read_b64_tr_b16 v[88:89], v25 offset:5120
    ds_read_b64_tr_b16 v[90:91], v25 offset:6400
    s_lshl_b32 s6, s33, 7
    s_lshl_b32 s7, s34, 2
    s_add_u32 s6, s6, s7
    s_mul_i32 s6, s6, 2304
    s_mul_i32 s7, s32, 1152
    s_waitcnt lgkmcnt(8)
    v_mfma_f32_32x32x16_bf16 v[92:107], v[72:75], a[100:103], v[92:107]
    ds_read_b128 a[104:107], v32 offset:0
    ds_read_b64_tr_b16 v[52:53], v23 offset:10240
    ds_read_b64_tr_b16 v[54:55], v23 offset:11520
    buffer_load_dwordx4 v11, s[12:15], s59 offen offset:1024 lds
    s_waitcnt lgkmcnt(9)
    v_mfma_f32_32x32x16_bf16 v[108:123], v[76:79], a[100:103], v[108:123]
    ds_read_b64_tr_b16 v[56:57], v23 offset:10304
    ds_read_b64_tr_b16 v[58:59], v23 offset:11584
    s_add_u32 s6, s6, s7
    s_add_u32 s78, s6, 1024
    s_mul_i32 s7, s35, 2304
    s_add_u32 s77, s6, s7
    s_lshr_b32 s82, s34, 2
    s_waitcnt lgkmcnt(9)
    v_mfma_f32_32x32x16_bf16 v[124:139], a[100:103], v[80:83], v[124:139]
    ds_read_b64_tr_b16 v[60:61], v23 offset:10384
    ds_read_b64_tr_b16 v[62:63], v23 offset:11664
    buffer_load_dwordx4 v12, s[12:15], s59 offen offset:2048 lds
    s_waitcnt lgkmcnt(9)
    v_mfma_f32_32x32x16_bf16 v[140:155], a[100:103], v[84:87], v[140:155]
    ds_read_b64_tr_b16 v[64:65], v23 offset:10448
    ds_read_b64_tr_b16 v[66:67], v23 offset:11728
    s_and_b32 s83, s34, 3
    s_lshl_b32 s7, s82, 1
    s_lshr_b32 s3, s35, 1
    s_add_u32 s3, s3, s7
    s_lshl_b32 s3, s3, 5
    s_waitcnt lgkmcnt(9)
    v_mfma_f32_32x32x16_bf16 v[156:171], v[88:91], a[100:103], v[156:171]
    ds_read_b64_tr_b16 v[68:69], v25 offset:10240
    ds_read_b64_tr_b16 v[70:71], v25 offset:11520
    buffer_load_dwordx4 v13, s[12:15], s59 offen offset:3072 lds
    s_waitcnt lgkmcnt(8)
    v_mfma_f32_32x32x16_bf16 v[92:107], v[52:55], a[104:107], v[92:107]
    ds_read_b128 a[108:111], v33 offset:0
    ds_read_b64_tr_b16 v[72:73], v23 offset:15360
    ds_read_b64_tr_b16 v[74:75], v23 offset:16640
    s_lshl_b32 s7, s33, 7
    s_add_u32 s3, s3, s7
    s_mul_i32 s84, s3, 2304
    s_mul_i32 s7, s32, 1152
    s_add_u32 s84, s84, s7
    s_waitcnt lgkmcnt(9)
    v_mfma_f32_32x32x16_bf16 v[108:123], v[56:59], a[104:107], v[108:123]
    ds_read_b64_tr_b16 v[76:77], v23 offset:15424
    ds_read_b64_tr_b16 v[78:79], v23 offset:16704
    s_add_u32 m0, s61, 4096
    s_nop 0
    buffer_load_dwordx4 v14, s[12:15], s59 offen lds
    s_add_u32 s58, s70, s76
    s_add_u32 s58, s58, 1
    s_sub_u32 s67, s58, 9
    s_cmp_ge_u32 s58, 9
    s_cselect_b32 s58, s67, s58
    s_add_u32 s76, s76, 1
    s_and_b32 s76, s76, 7
    s_mul_i32 s59, s58, 221184
    s_lshl_b32 s60, s58, 7
    s_waitcnt lgkmcnt(9)
    v_mfma_f32_32x32x16_bf16 v[124:139], a[104:107], v[60:63], v[124:139]
    ds_read_b64_tr_b16 v[80:81], v23 offset:15504
    ds_read_b64_tr_b16 v[82:83], v23 offset:16784
    s_add_u32 s85, s84, 1024
    s_lshl_b32 s6, s33, 7
    s_lshl_b32 s7, s82, 6
    s_add_u32 s6, s6, s7
    s_lshl_b32 s7, s35, 4
    s_waitcnt lgkmcnt(9)
    v_mfma_f32_32x32x16_bf16 v[140:155], a[104:107], v[64:67], v[140:155]
    ds_read_b64_tr_b16 v[84:85], v23 offset:15568
    ds_read_b64_tr_b16 v[86:87], v23 offset:16848
    s_add_u32 s6, s6, s7
    s_mul_i32 s86, s6, 2304
    s_mul_i32 s7, s32, 1152
    s_add_u32 s86, s86, s7
    s_mul_i32 s7, s83, 288
    s_waitcnt lgkmcnt(9)
    v_mfma_f32_32x32x16_bf16 v[156:171], v[68:71], a[104:107], v[156:171]
    ds_read_b64_tr_b16 v[88:89], v25 offset:15360
    ds_read_b64_tr_b16 v[90:91], v25 offset:16640
    s_add_u32 s86, s86, s7
    s_lshl_b32 s6, s32, 4
    s_add_u32 s6, s6, s33
    s_lshl_b32 s79, s6, 12
    s_add_u32 s79, s79, 25427968
    s_waitcnt vmcnt(9)
    s_barrier
    s_waitcnt lgkmcnt(8)
    v_mfma_f32_32x32x16_bf16 v[92:107], v[72:75], a[108:111], v[92:107]
    ds_read_b128 a[112:115], v30 offset:36864
    ds_read_b64_tr_b16 v[52:53], v23 offset:36864
    ds_read_b64_tr_b16 v[54:55], v23 offset:38144
    s_mov_b32 s58, s70
    s_mul_i32 s59, s58, 221184
    s_mov_b32 s76, s81
    s_waitcnt lgkmcnt(9)
    v_mfma_f32_32x32x16_bf16 v[108:123], v[76:79], a[108:111], v[108:123]
    ds_read_b64_tr_b16 v[56:57], v23 offset:36928
    ds_read_b64_tr_b16 v[58:59], v23 offset:38208
    v_mov_b32 v252, 0x2b800000
    v_mov_b32 v253, 0x53800000
    s_mov_b64 s[74:75], 0
    s_mul_i32 s6, s83, 288
    v_lshrrev_b32 v4, 4, v1
    s_waitcnt lgkmcnt(9)
    v_mfma_f32_32x32x16_bf16 v[124:139], a[108:111], v[80:83], v[124:139]
    ds_read_b64_tr_b16 v[60:61], v23 offset:37008
    ds_read_b64_tr_b16 v[62:63], v23 offset:38288
    s_mul_i32 s61, s35, 3072
    s_add_u32 m0, s61, 36864
    s_nop 0
    buffer_load_dwordx4 v19, s[12:15], s59 offen offset:0 lds
    s_waitcnt lgkmcnt(9)
    v_mfma_f32_32x32x16_bf16 v[140:155], a[108:111], v[84:87], v[140:155]
    ds_read_b64_tr_b16 v[64:65], v23 offset:37072
    ds_read_b64_tr_b16 v[66:67], v23 offset:38352
    v_and_b32 v5, 15, v1
    v_add_u32 v6, 0, v4
    v_lshlrev_b32 v6, 1, v6
    v_xor_b32 v6, v5, v6
    v_lshlrev_b32 v6, 4, v6
    s_waitcnt lgkmcnt(9)
    v_mfma_f32_32x32x16_bf16 v[156:171], v[88:91], a[108:111], v[156:171]
    ds_read_b64_tr_b16 v[68:69], v25 offset:36864
    ds_read_b64_tr_b16 v[70:71], v25 offset:38144
    buffer_load_dwordx4 v20, s[12:15], s59 offen offset:1024 lds
    s_waitcnt lgkmcnt(8)
    v_mfma_f32_32x32x16_bf16 v[92:107], v[52:55], a[112:115], v[92:107]
    ds_read_b128 a[116:119], v31 offset:36864
    ds_read_b64_tr_b16 v[72:73], v23 offset:41984
    ds_read_b64_tr_b16 v[74:75], v23 offset:43264
    v_add_u32 v6, s6, v6
    v_mul_u32_u24 v7, 1152, v4
    v_add_u32 v220, v6, v7
    v_lshrrev_b32 v7, 1, v4
    v_mul_u32_u24 v7, 18, v7
    s_waitcnt lgkmcnt(9)
    v_mfma_f32_32x32x16_bf16 v[108:123], v[56:59], a[112:115], v[108:123]
    ds_read_b64_tr_b16 v[76:77], v23 offset:42048
    ds_read_b64_tr_b16 v[78:79], v23 offset:43328
    buffer_load_dwordx4 v21, s[12:15], s59 offen offset:2048 lds
    s_add_u32 s58, s70, s76
    s_add_u32 s58, s58, 1
    s_sub_u32 s67, s58, 9
    s_cmp_ge_u32 s58, 9
    s_cselect_b32 s58, s67, s58
    s_add_u32 s76, s76, 1
    s_and_b32 s76, s76, 7
    s_mul_i32 s59, s58, 221184
    s_lshl_b32 s60, s58, 7
    s_waitcnt lgkmcnt(9)
    v_mfma_f32_32x32x16_bf16 v[124:139], a[112:115], v[60:63], v[124:139]
    ds_read_b64_tr_b16 v[80:81], v23 offset:42128
    ds_read_b64_tr_b16 v[82:83], v23 offset:43408
    v_and_b32 v8, 1, v4
    v_add_u32 v7, v7, v8
    v_mul_u32_u24 v7, 1152, v7
    v_add_u32 v222, v6, v7
    v_add_u32 v6, 4, v4
    s_waitcnt lgkmcnt(9)
    v_mfma_f32_32x32x16_bf16 v[140:155], a[112:115], v[64:67], v[140:155]
    ds_read_b64_tr_b16 v[84:85], v23 offset:42192
    ds_read_b64_tr_b16 v[86:87], v23 offset:43472
    s_mul_i32 s61, s35, 3072
    s_add_u32 m0, s61, 49152
    s_nop 0
    buffer_load_dwordx4 v19, s[12:15], s59 offen offset:0 lds
    s_waitcnt lgkmcnt(9)
    v_mfma_f32_32x32x16_bf16 v[156:171], v[68:71], a[112:115], v[156:171]
    ds_read_b64_tr_b16 v[88:89], v25 offset:41984
    ds_read_b64_tr_b16 v[90:91], v25 offset:43264
    v_lshlrev_b32 v6, 1, v6
    v_xor_b32 v6, v5, v6
    v_lshlrev_b32 v6, 4, v6
    v_add_u32 v6, s6, v6
    v_mul_u32_u24 v7, 1152, v4
    s_waitcnt lgkmcnt(8)
    v_mfma_f32_32x32x16_bf16 v[92:107], v[72:75], a[116:119], v[92:107]
    ds_read_b128 a[120:123], v32 offset:36864
    ds_read_b64_tr_b16 v[52:53], v23 offset:47104
    ds_read_b64_tr_b16 v[54:55], v23 offset:48384
    buffer_load_dwordx4 v20, s[12:15], s59 offen offset:1024 lds
    s_waitcnt lgkmcnt(9)
    v_mfma_f32_32x32x16_bf16 v[108:123], v[76:79], a[116:119], v[108:123]
    ds_read_b64_tr_b16 v[56:57], v23 offset:47168
    ds_read_b64_tr_b16 v[58:59], v23 offset:48448
    v_add_u32 v221, v6, v7
    v_lshrrev_b32 v7, 1, v4
    v_mul_u32_u24 v7, 18, v7
    v_and_b32 v8, 1, v4
    v_add_u32 v7, v7, v8
    s_waitcnt lgkmcnt(9)
    v_mfma_f32_32x32x16_bf16 v[124:139], a[116:119], v[80:83], v[124:139]
    ds_read_b64_tr_b16 v[60:61], v23 offset:47248
    ds_read_b64_tr_b16 v[62:63], v23 offset:48528
    buffer_load_dwordx4 v21, s[12:15], s59 offen offset:2048 lds
    s_add_u32 s58, s70, s76
    s_add_u32 s58, s58, 1
    s_sub_u32 s67, s58, 9
    s_cmp_ge_u32 s58, 9
    s_cselect_b32 s58, s67, s58
    s_add_u32 s76, s76, 1
    s_and_b32 s76, s76, 7
    s_mul_i32 s59, s58, 221184
    s_lshl_b32 s60, s58, 7
    s_waitcnt lgkmcnt(9)
    v_mfma_f32_32x32x16_bf16 v[140:155], a[116:119], v[84:87], v[140:155]
    ds_read_b64_tr_b16 v[64:65], v23 offset:47312
    ds_read_b64_tr_b16 v[66:67], v23 offset:48592
    v_mul_u32_u24 v7, 1152, v7
    v_add_u32 v223, v6, v7
    v_lshrrev_b32 v4, 1, v1
    v_and_b32 v5, 1, v1
    v_lshlrev_b32 v5, 4, v5
    s_waitcnt lgkmcnt(9)
    v_mfma_f32_32x32x16_bf16 v[156:171], v[88:91], a[116:119], v[156:171]
    ds_read_b64_tr_b16 v[68:69], v25 offset:47104
    ds_read_b64_tr_b16 v[70:71], v25 offset:48384
    s_mul_i32 s61, s35, 3072
    s_add_u32 m0, s61, 61440
    s_nop 0
    buffer_load_dwordx4 v19, s[12:15], s59 offen offset:0 lds
    s_waitcnt lgkmcnt(8)
    v_mfma_f32_32x32x16_bf16 v[92:107], v[52:55], a[120:123], v[92:107]
    ds_read_b128 a[124:127], v33 offset:36864
    ds_read_b64_tr_b16 v[72:73], v23 offset:52224
    ds_read_b64_tr_b16 v[74:75], v23 offset:53504
    v_add_u32 v5, 256, v5
    v_add_u32 v5, s6, v5
    v_bfe_u32 v6, v4, 2, 2
    v_and_b32 v7, 3, v4
    v_lshrrev_b32 v8, 4, v4
    s_waitcnt lgkmcnt(9)
    v_mfma_f32_32x32x16_bf16 v[108:123], v[56:59], a[120:123], v[108:123]
    ds_read_b64_tr_b16 v[76:77], v23 offset:52288
    ds_read_b64_tr_b16 v[78:79], v23 offset:53568
    buffer_load_dwordx4 v20, s[12:15], s59 offen offset:1024 lds
    s_waitcnt lgkmcnt(9)
    v_mfma_f32_32x32x16_bf16 v[124:139], a[120:123], v[60:63], v[124:139]
    ds_read_b64_tr_b16 v[80:81], v23 offset:52368
    ds_read_b64_tr_b16 v[82:83], v23 offset:53648
    v_lshrrev_b32 v2, 1, v6
    v_mul_u32_u24 v2, 18, v2
    v_add_u32 v2, v2, v7
    v_lshl_add_u32 v2, v8, 3, v2
    v_and_b32 v3, 1, v6
    s_waitcnt lgkmcnt(9)
    v_mfma_f32_32x32x16_bf16 v[140:155], a[120:123], v[64:67], v[140:155]
    ds_read_b64_tr_b16 v[84:85], v23 offset:52432
    ds_read_b64_tr_b16 v[86:87], v23 offset:53712
    buffer_load_dwordx4 v21, s[12:15], s59 offen offset:2048 lds
    s_add_u32 s58, s70, s76
    s_add_u32 s58, s58, 1
    s_sub_u32 s67, s58, 9
    s_cmp_ge_u32 s58, 9
    s_cselect_b32 s58, s67, s58
    s_add_u32 s76, s76, 1
    s_and_b32 s76, s76, 7
    s_mul_i32 s59, s58, 221184
    s_lshl_b32 s60, s58, 7
    s_waitcnt lgkmcnt(9)
    v_mfma_f32_32x32x16_bf16 v[156:171], v[68:71], a[120:123], v[156:171]
    ds_read_b64_tr_b16 v[88:89], v25 offset:52224
    ds_read_b64_tr_b16 v[90:91], v25 offset:53504
    v_lshl_add_u32 v2, v3, 2, v2
    v_mul_u32_u24 v2, 1152, v2
    v_add_u32 v224, v2, v5
    v_lshl_add_u32 v7, v8, 2, v7
    v_lshrrev_b32 v2, 1, v7
    v_mov_b32 v51, 0
    buffer_load_dwordx2 v[48:49], v51, s[28:31], 0 offen sc1
    s_waitcnt vmcnt(10)
    s_barrier
    s_waitcnt lgkmcnt(8)
    v_mfma_f32_32x32x16_bf16 v[92:107], v[72:75], a[124:127], v[92:107]
    ds_read_b128 a[128:131], v26 offset:0
    ds_read_b64_tr_b16 v[52:53], v22 offset:0
    ds_read_b64_tr_b16 v[54:55], v22 offset:1280
    s_mul_i32 s61, s35, 3072
    s_add_u32 m0, s61, 73728
    s_nop 0
    buffer_load_dwordx4 v19, s[12:15], s59 offen offset:0 lds
    s_waitcnt lgkmcnt(9)
    v_mfma_f32_32x32x16_bf16 v[108:123], v[76:79], a[124:127], v[108:123]
    ds_read_b64_tr_b16 v[56:57], v22 offset:64
    ds_read_b64_tr_b16 v[58:59], v22 offset:1344
    v_lshl_add_u32 v2, v6, 2, v2
    v_mul_u32_u24 v2, 18, v2
    v_and_b32 v3, 1, v7
    v_add3_u32 v2, v2, v3, 16
    v_mul_u32_u24 v2, 1152, v2
    s_waitcnt lgkmcnt(9)
    v_mfma_f32_32x32x16_bf16 v[124:139], a[124:127], v[80:83], v[124:139]
    ds_read_b64_tr_b16 v[60:61], v22 offset:144
    ds_read_b64_tr_b16 v[62:63], v22 offset:1424
    buffer_load_dwordx4 v20, s[12:15], s59 offen offset:1024 lds
    s_waitcnt lgkmcnt(9)
    v_mfma_f32_32x32x16_bf16 v[140:155], a[124:127], v[84:87], v[140:155]
    ds_read_b64_tr_b16 v[64:65], v22 offset:208
    ds_read_b64_tr_b16 v[66:67], v22 offset:1488
    v_add_u32 v225, v2, v5
    s_waitcnt lgkmcnt(9)
    v_mfma_f32_32x32x16_bf16 v[156:171], v[88:91], a[124:127], v[156:171]
    ds_read_b64_tr_b16 v[68:69], v24 offset:0
    ds_read_b64_tr_b16 v[70:71], v24 offset:1280
    buffer_load_dwordx4 v21, s[12:15], s59 offen offset:2048 lds
    s_add_u32 s58, s70, s76
    s_add_u32 s58, s58, 1
    s_sub_u32 s67, s58, 9
    s_cmp_ge_u32 s58, 9
    s_cselect_b32 s58, s67, s58
    s_add_u32 s76, s76, 1
    s_and_b32 s76, s76, 7
    s_mul_i32 s59, s58, 221184
    s_lshl_b32 s60, s58, 7
    s_waitcnt lgkmcnt(8)
    v_mfma_f32_32x32x16_bf16 v[92:107], v[52:55], a[128:131], v[92:107]
    ds_read_b128 a[132:135], v27 offset:0
    ds_read_b64_tr_b16 v[72:73], v22 offset:5120
    ds_read_b64_tr_b16 v[74:75], v22 offset:6400
    s_waitcnt lgkmcnt(9)
    v_mfma_f32_32x32x16_bf16 v[108:123], v[56:59], a[128:131], v[108:123]
    ds_read_b64_tr_b16 v[76:77], v22 offset:5184
    ds_read_b64_tr_b16 v[78:79], v22 offset:6464
    s_mul_i32 s61, s35, 3072
    s_add_u32 m0, s61, 86016
    s_nop 0
    buffer_load_dwordx4 v19, s[12:15], s59 offen offset:0 lds
    s_waitcnt lgkmcnt(9)
    v_mfma_f32_32x32x16_bf16 v[124:139], a[128:131], v[60:63], v[124:139]
    ds_read_b64_tr_b16 v[80:81], v22 offset:5264
    ds_read_b64_tr_b16 v[82:83], v22 offset:6544
    s_waitcnt lgkmcnt(9)
    v_mfma_f32_32x32x16_bf16 v[140:155], a[128:131], v[64:67], v[140:155]
    ds_read_b64_tr_b16 v[84:85], v22 offset:5328
    ds_read_b64_tr_b16 v[86:87], v22 offset:6608
    buffer_load_dwordx4 v20, s[12:15], s59 offen offset:1024 lds
    s_waitcnt lgkmcnt(9)
    v_mfma_f32_32x32x16_bf16 v[156:171], v[68:71], a[128:131], v[156:171]
    ds_read_b64_tr_b16 v[88:89], v24 offset:5120
    ds_read_b64_tr_b16 v[90:91], v24 offset:6400
    s_waitcnt lgkmcnt(8)
    v_mfma_f32_32x32x16_bf16 v[92:107], v[72:75], a[132:135], v[92:107]
    ds_read_b128 a[136:139], v28 offset:0
    ds_read_b64_tr_b16 v[52:53], v22 offset:10240
    ds_read_b64_tr_b16 v[54:55], v22 offset:11520
    buffer_load_dwordx4 v21, s[12:15], s59 offen offset:2048 lds
    s_add_u32 s58, s70, s76
    s_add_u32 s58, s58, 1
    s_sub_u32 s67, s58, 9
    s_cmp_ge_u32 s58, 9
    s_cselect_b32 s58, s67, s58
    s_add_u32 s76, s76, 1
    s_and_b32 s76, s76, 7
    s_mul_i32 s59, s58, 221184
    s_lshl_b32 s60, s58, 7
    s_waitcnt lgkmcnt(9)
    v_mfma_f32_32x32x16_bf16 v[108:123], v[76:79], a[132:135], v[108:123]
    ds_read_b64_tr_b16 v[56:57], v22 offset:10304
    ds_read_b64_tr_b16 v[58:59], v22 offset:11584
    s_waitcnt lgkmcnt(9)
    v_mfma_f32_32x32x16_bf16 v[124:139], a[132:135], v[80:83], v[124:139]
    ds_read_b64_tr_b16 v[60:61], v22 offset:10384
    ds_read_b64_tr_b16 v[62:63], v22 offset:11664
    s_mul_i32 s61, s35, 3072
    s_add_u32 m0, s61, 98304
    s_nop 0
    buffer_load_dwordx4 v19, s[12:15], s59 offen offset:0 lds
    s_waitcnt lgkmcnt(9)
    v_mfma_f32_32x32x16_bf16 v[140:155], a[132:135], v[84:87], v[140:155]
    ds_read_b64_tr_b16 v[64:65], v22 offset:10448
    ds_read_b64_tr_b16 v[66:67], v22 offset:11728
    s_waitcnt lgkmcnt(9)
    v_mfma_f32_32x32x16_bf16 v[156:171], v[88:91], a[132:135], v[156:171]
    ds_read_b64_tr_b16 v[68:69], v24 offset:10240
    ds_read_b64_tr_b16 v[70:71], v24 offset:11520
    buffer_load_dwordx4 v20, s[12:15], s59 offen offset:1024 lds
    s_waitcnt lgkmcnt(8)
    v_mfma_f32_32x32x16_bf16 v[92:107], v[52:55], a[136:139], v[92:107]
    ds_read_b128 a[140:143], v29 offset:0
    ds_read_b64_tr_b16 v[72:73], v22 offset:15360
    ds_read_b64_tr_b16 v[74:75], v22 offset:16640
    s_waitcnt lgkmcnt(9)
    v_mfma_f32_32x32x16_bf16 v[108:123], v[56:59], a[136:139], v[108:123]
    ds_read_b64_tr_b16 v[76:77], v22 offset:15424
    ds_read_b64_tr_b16 v[78:79], v22 offset:16704
    buffer_load_dwordx4 v21, s[12:15], s59 offen offset:2048 lds
    s_add_u32 s58, s70, s76
    s_add_u32 s58, s58, 1
    s_sub_u32 s67, s58, 9
    s_cmp_ge_u32 s58, 9
    s_cselect_b32 s58, s67, s58
    s_add_u32 s76, s76, 1
    s_and_b32 s76, s76, 7
    s_mul_i32 s59, s58, 221184
    s_lshl_b32 s60, s58, 7
    s_waitcnt lgkmcnt(9)
    v_mfma_f32_32x32x16_bf16 v[124:139], a[136:139], v[60:63], v[124:139]
    ds_read_b64_tr_b16 v[80:81], v22 offset:15504
    ds_read_b64_tr_b16 v[82:83], v22 offset:16784
    s_waitcnt lgkmcnt(9)
    v_mfma_f32_32x32x16_bf16 v[140:155], a[136:139], v[64:67], v[140:155]
    ds_read_b64_tr_b16 v[84:85], v22 offset:15568
    ds_read_b64_tr_b16 v[86:87], v22 offset:16848
    s_waitcnt lgkmcnt(9)
    v_mfma_f32_32x32x16_bf16 v[156:171], v[68:71], a[136:139], v[156:171]
    ds_read_b64_tr_b16 v[88:89], v24 offset:15360
    ds_read_b64_tr_b16 v[90:91], v24 offset:16640
    s_waitcnt vmcnt(16)
    s_barrier
    s_waitcnt lgkmcnt(8)
    v_mfma_f32_32x32x16_bf16 v[92:107], v[72:75], a[140:143], v[92:107]
    ds_read_b64_tr_b16 v[52:53], v34 offset:0
    ds_read_b64_tr_b16 v[54:55], v34 offset:768
    s_mul_i32 s61, s35, 3072
    s_add_u32 m0, s61, 110592
    s_nop 0
    buffer_load_dwordx4 v19, s[12:15], s59 offen offset:0 lds
    s_waitcnt lgkmcnt(8)
    v_mfma_f32_32x32x16_bf16 v[108:123], v[76:79], a[140:143], v[108:123]
    ds_read_b64_tr_b16 v[56:57], v34 offset:64
    ds_read_b64_tr_b16 v[58:59], v34 offset:832
    s_waitcnt lgkmcnt(8)
    v_mfma_f32_32x32x16_bf16 v[124:139], a[140:143], v[80:83], v[124:139]
    ds_read_b64_tr_b16 v[60:61], v43 offset:0
    ds_read_b64_tr_b16 v[62:63], v43 offset:768
    buffer_load_dwordx4 v20, s[12:15], s59 offen offset:1024 lds
    s_waitcnt lgkmcnt(8)
    v_mfma_f32_32x32x16_bf16 v[140:155], a[140:143], v[84:87], v[140:155]
    s_waitcnt lgkmcnt(6)
    v_mfma_f32_32x32x16_bf16 v[156:171], v[88:91], a[140:143], v[156:171]
    buffer_load_dwordx4 v21, s[12:15], s59 offen offset:2048 lds
    s_add_u32 s58, s70, s76
    s_add_u32 s58, s58, 1
    s_sub_u32 s67, s58, 9
    s_cmp_ge_u32 s58, 9
    s_cselect_b32 s58, s67, s58
    s_add_u32 s76, s76, 1
    s_and_b32 s76, s76, 7
    s_mul_i32 s59, s58, 221184
    s_lshl_b32 s60, s58, 7
    s_waitcnt lgkmcnt(4)
    v_mfma_f32_32x32x16_bf16 v[172:187], v[52:55], a[0:3], 0
    ds_read_b64_tr_b16 v[64:65], v34 offset:3072
    ds_read_b64_tr_b16 v[66:67], v34 offset:3840
    s_mul_i32 s61, s35, 3072
    s_add_u32 m0, s61, 122880
    s_nop 0
    buffer_load_dwordx4 v19, s[12:15], s59 offen offset:0 lds
    s_waitcnt lgkmcnt(4)
    v_mfma_f32_32x32x16_bf16 v[188:203], v[56:59], a[0:3], 0
    ds_read_b64_tr_b16 v[68:69], v34 offset:3136
    ds_read_b64_tr_b16 v[70:71], v34 offset:3904
    buffer_load_dwordx4 v20, s[12:15], s59 offen offset:1024 lds
    s_waitcnt lgkmcnt(4)
    v_mfma_f32_16x16x32_bf16 v[204:207], v[60:63], a[0:3], 0
    ds_read_b64_tr_b16 v[72:73], v43 offset:3072
    ds_read_b64_tr_b16 v[74:75], v43 offset:3840
    buffer_load_dwordx4 v21, s[12:15], s59 offen offset:2048 lds
    s_add_u32 s58, s70, s76
    s_add_u32 s58, s58, 1
    s_sub_u32 s67, s58, 9
    s_cmp_ge_u32 s58, 9
    s_cselect_b32 s58, s67, s58
    s_add_u32 s76, s76, 1
    s_and_b32 s76, s76, 7
    s_mul_i32 s59, s58, 221184
    s_lshl_b32 s60, s58, 7
    s_barrier
    s_waitcnt lgkmcnt(4)
    v_mfma_f32_32x32x16_bf16 v[172:187], v[64:67], a[4:7], v[172:187]
    ds_read_b64_tr_b16 v[52:53], v34 offset:6144
    ds_read_b64_tr_b16 v[54:55], v34 offset:6912
    v_cvt_pk_bf16_f32 v76, v92, v93
    v_cvt_pk_bf16_f32 v77, v94, v95
    ds_write2_b32 v35, v76, v77 offset0:0 offset1:1
    v_cvt_pk_bf16_f32 v78, v96, v97
    v_cvt_pk_bf16_f32 v79, v98, v99
    ds_write2_b32 v35, v78, v79 offset0:4 offset1:5
    v_cvt_pk_bf16_f32 v76, v100, v101
    s_waitcnt lgkmcnt(6)
    v_mfma_f32_32x32x16_bf16 v[188:203], v[68:71], a[4:7], v[188:203]
    ds_read_b64_tr_b16 v[56:57], v34 offset:6208
    ds_read_b64_tr_b16 v[58:59], v34 offset:6976
    v_cvt_pk_bf16_f32 v77, v102, v103
    ds_write2_b32 v35, v76, v77 offset0:8 offset1:9
    v_cvt_pk_bf16_f32 v78, v104, v105
    v_cvt_pk_bf16_f32 v79, v106, v107
    ds_write2_b32 v35, v78, v79 offset0:12 offset1:13
    v_cvt_pk_bf16_f32 v76, v108, v109
    v_cvt_pk_bf16_f32 v77, v110, v111
    s_waitcnt lgkmcnt(8)
    v_mfma_f32_16x16x32_bf16 v[204:207], v[72:75], a[4:7], v[204:207]
    ds_read_b64_tr_b16 v[60:61], v43 offset:6144
    ds_read_b64_tr_b16 v[62:63], v43 offset:6912
    ds_write2_b32 v35, v76, v77 offset0:16 offset1:17
    v_cvt_pk_bf16_f32 v78, v112, v113
    v_cvt_pk_bf16_f32 v79, v114, v115
    ds_write2_b32 v35, v78, v79 offset0:20 offset1:21
    v_cvt_pk_bf16_f32 v76, v116, v117
    v_cvt_pk_bf16_f32 v77, v118, v119
    ds_write2_b32 v35, v76, v77 offset0:24 offset1:25
    s_waitcnt lgkmcnt(11)
    v_mfma_f32_32x32x16_bf16 v[172:187], v[52:55], a[8:11], v[172:187]
    ds_read_b64_tr_b16 v[64:65], v34 offset:9216
    ds_read_b64_tr_b16 v[66:67], v34 offset:9984
    v_cvt_pk_bf16_f32 v78, v120, v121
    v_cvt_pk_bf16_f32 v79, v122, v123
    ds_write2_b32 v35, v78, v79 offset0:28 offset1:29
    v_cvt_pk_bf16_f32 v80, v124, v125
    v_cvt_pk_bf16_f32 v81, v126, v127
    v_cvt_pk_bf16_f32 v82, v128, v129
    v_cvt_pk_bf16_f32 v83, v130, v131
    s_waitcnt lgkmcnt(10)
    v_mfma_f32_32x32x16_bf16 v[188:203], v[56:59], a[8:11], v[188:203]
    ds_read_b64_tr_b16 v[68:69], v34 offset:9280
    ds_read_b64_tr_b16 v[70:71], v34 offset:10048
    ds_write_b128 v37, v[80:83] offset:0
    v_cvt_pk_bf16_f32 v84, v132, v133
    v_cvt_pk_bf16_f32 v85, v134, v135
    v_cvt_pk_bf16_f32 v86, v136, v137
    v_cvt_pk_bf16_f32 v87, v138, v139
    ds_write_b128 v37, v[84:87] offset:2368
    v_cvt_pk_bf16_f32 v80, v140, v141
    s_waitcnt lgkmcnt(10)
    v_mfma_f32_16x16x32_bf16 v[204:207], v[60:63], a[8:11], v[204:207]
    ds_read_b64_tr_b16 v[72:73], v43 offset:9216
    ds_read_b64_tr_b16 v[74:75], v43 offset:9984
    v_cvt_pk_bf16_f32 v81, v142, v143
    v_cvt_pk_bf16_f32 v82, v144, v145
    v_cvt_pk_bf16_f32 v83, v146, v147
    ds_write_b128 v37, v[80:83] offset:512
    v_cvt_pk_bf16_f32 v84, v148, v149
    v_cvt_pk_bf16_f32 v85, v150, v151
    v_cvt_pk_bf16_f32 v86, v152, v153
    s_waitcnt vmcnt(19)
    s_barrier
    s_waitcnt lgkmcnt(8)
    v_mfma_f32_32x32x16_bf16 v[172:187], v[64:67], a[12:15], v[172:187]
    ds_read_b64_tr_b16 v[52:53], v34 offset:12288
    ds_read_b64_tr_b16 v[54:55], v34 offset:13056
    v_cvt_pk_bf16_f32 v87, v154, v155
    ds_write_b128 v37, v[84:87] offset:2880
    v_cvt_pk_bf16_f32 v88, v156, v157
    v_cvt_pk_bf16_f32 v89, v158, v159
    ds_write2_b32 v35, v88, v89 offset0:32 offset1:33
    v_cvt_pk_bf16_f32 v90, v160, v161
    v_cvt_pk_bf16_f32 v91, v162, v163
    s_waitcnt lgkmcnt(9)
    v_mfma_f32_32x32x16_bf16 v[188:203], v[68:71], a[12:15], v[188:203]
    ds_read_b64_tr_b16 v[56:57], v34 offset:12352
    ds_read_b64_tr_b16 v[58:59], v34 offset:13120
    ds_write_b16 v38, v90
    ds_write_b16_d16_hi v38, v90 offset:16
    ds_write_b16 v38, v91 offset:32
    ds_write_b16_d16_hi v38, v91 offset:48
    v_and_b32 v88, 1, v1
    v_cmp_eq_u32 vcc, 0, v88
    v_mov_b32 v89, 0x3f803f80
    s_waitcnt lgkmcnt(11)
    v_mfma_f32_16x16x32_bf16 v[204:207], v[72:75], a[12:15], v[204:207]
    ds_read_b64_tr_b16 v[60:61], v43 offset:12288
    ds_read_b64_tr_b16 v[62:63], v43 offset:13056
    s_nop 0
    v_cndmask_b32 v88, 0, v89, vcc
    v_mov_b32 v89, v88
    v_mov_b32 v90, v88
    v_mov_b32 v91, v88
    s_mov_b64 exec, 0xff
    ds_write_b128 v42, v[88:91]
    s_mov_b64 exec, -1
    s_waitcnt lgkmcnt(0)
    s_barrier
    v_add_u32 v88, 147456, v39
    v_add_u32 v89, 147456, v40
    ds_read2_b32 v[92:93], v88 offset0:0 offset1:1
    ds_read2_b32 v[94:95], v88 offset0:2 offset1:3
    ds_read_b32 v96, v89
    v_add_u32 v88, 152192, v39
    v_add_u32 v89, 152192, v40
    ds_read2_b32 v[106:107], v88 offset0:0 offset1:1
    ds_read2_b32 v[108:109], v88 offset0:2 offset1:3
    ds_read_b32 v110, v89
    v_add_u32 v88, 156928, v39
    v_add_u32 v89, 156928, v40
    ds_read2_b32 v[120:121], v88 offset0:0 offset1:1
    ds_read2_b32 v[122:123], v88 offset0:2 offset1:3
    ds_read_b32 v124, v89
    v_add_u32 v88, 18944, v39
    v_add_u32 v89, 18944, v40
    ds_read2_b32 v[134:135], v88 offset0:0 offset1:1
    ds_read2_b32 v[136:137], v88 offset0:2 offset1:3
    ds_read_b32 v138, v89
    ds_read_b128 v[98:101], v41 offset:0
    ds_read_b128 v[102:105], v41 offset:2368
    ds_read_b128 v[112:115], v41 offset:4736
    ds_read_b128 v[116:119], v41 offset:7104
    ds_read_b128 v[126:129], v41 offset:9472
    ds_read_b128 v[130:133], v41 offset:11840
    ds_read_b128 v[140:143], v41 offset:14208
    ds_read_b128 v[144:147], v41 offset:16576
    v_mfma_f32_32x32x16_bf16 v[172:187], v[52:55], a[16:19], v[172:187]
    ds_read_b64_tr_b16 v[64:65], v34 offset:15360
    ds_read_b64_tr_b16 v[66:67], v34 offset:16128
    s_mul_i32 s61, s35, 3072
    s_add_u32 m0, s61, 135168
    s_nop 0
    buffer_load_dwordx4 v19, s[12:15], s59 offen offset:0 lds
    v_mfma_f32_32x32x16_bf16 v[188:203], v[56:59], a[16:19], v[188:203]
    ds_read_b64_tr_b16 v[68:69], v34 offset:15424
    ds_read_b64_tr_b16 v[70:71], v34 offset:16192
    buffer_load_dwordx4 v20, s[12:15], s59 offen offset:1024 lds
    v_mfma_f32_16x16x32_bf16 v[204:207], v[60:63], a[16:19], v[204:207]
    ds_read_b64_tr_b16 v[72:73], v43 offset:15360
    ds_read_b64_tr_b16 v[74:75], v43 offset:16128
    buffer_load_dwordx4 v21, s[12:15], s59 offen offset:2048 lds
    s_add_u32 s58, s70, s76
    s_add_u32 s58, s58, 1
    s_sub_u32 s67, s58, 9
    s_cmp_ge_u32 s58, 9
    s_cselect_b32 s58, s67, s58
    s_add_u32 s76, s76, 1
    s_and_b32 s76, s76, 7
    s_mul_i32 s59, s58, 221184
    s_lshl_b32 s60, s58, 7
    s_waitcnt lgkmcnt(6)
    s_waitcnt lgkmcnt(4)
    v_mfma_f32_32x32x16_bf16 v[172:187], v[64:67], a[20:23], v[172:187]
    ds_read_b64_tr_b16 v[52:53], v34 offset:18432
    ds_read_b64_tr_b16 v[54:55], v34 offset:19200
    s_add_u32 s63, s62, 0
    buffer_store_dwordx4 v[92:95], v44, s[24:27], s63 offen sc1
    s_waitcnt lgkmcnt(4)
    v_mfma_f32_32x32x16_bf16 v[188:203], v[68:71], a[20:23], v[188:203]
    ds_read_b64_tr_b16 v[56:57], v34 offset:18496
    ds_read_b64_tr_b16 v[58:59], v34 offset:19264
    v_mov_b32 v10, v220
    v_mov_b32 v11, v221
    v_mov_b32 v12, v222
    v_mov_b32 v13, v223
    s_waitcnt lgkmcnt(4)
    v_mfma_f32_16x16x32_bf16 v[204:207], v[72:75], a[20:23], v[204:207]
    ds_read_b64_tr_b16 v[60:61], v43 offset:18432
    ds_read_b64_tr_b16 v[62:63], v43 offset:19200
    v_mov_b32 v14, v224
    v_mov_b32 v15, v225
    v_add_u32 v22, 0, v10
    v_add_u32 v23, 3584, v11
    s_waitcnt lgkmcnt(4)
    v_mfma_f32_32x32x16_bf16 v[172:187], v[52:55], a[24:27], v[172:187]
    ds_read_b64_tr_b16 v[64:65], v34 offset:21504
    ds_read_b64_tr_b16 v[66:67], v34 offset:22272
    s_add_u32 s63, s62, 0
    s_mov_b64 exec, s[56:57]
    buffer_store_dword v96, v45, s[24:27], s63 offen sc1
    s_mov_b64 exec, -1
    s_waitcnt lgkmcnt(4)
    v_mfma_f32_32x32x16_bf16 v[188:203], v[56:59], a[24:27], v[188:203]
    ds_read_b64_tr_b16 v[68:69], v34 offset:21568
    ds_read_b64_tr_b16 v[70:71], v34 offset:22336
    v_add_u32 v24, 18688, v10
    v_add_u32 v25, 22272, v11
    v_add_u32 v26, 9216, v10
    v_add_u32 v27, 12800, v11
    s_waitcnt lgkmcnt(4)
    v_mfma_f32_16x16x32_bf16 v[204:207], v[60:63], a[24:27], v[204:207]
    ds_read_b64_tr_b16 v[72:73], v43 offset:21504
    ds_read_b64_tr_b16 v[74:75], v43 offset:22272
    v_add_u32 v28, 27904, v10
    v_add_u32 v29, 31488, v11
    s_barrier
    s_waitcnt vmcnt(21)
    s_barrier
    s_waitcnt lgkmcnt(4)
    v_mfma_f32_32x32x16_bf16 v[172:187], v[64:67], a[28:31], v[172:187]
    ds_read_b64_tr_b16 v[52:53], v34 offset:24576
    ds_read_b64_tr_b16 v[54:55], v34 offset:25344
    s_add_u32 s63, s62, 0
    s_mov_b64 exec, s[54:55]
    buffer_store_dwordx4 v[98:101], v46, s[24:27], s63 offen offset:0 sc1
    s_mov_b64 exec, -1
    s_waitcnt lgkmcnt(4)
    v_mfma_f32_32x32x16_bf16 v[188:203], v[68:71], a[28:31], v[188:203]
    ds_read_b64_tr_b16 v[56:57], v34 offset:24640
    ds_read_b64_tr_b16 v[58:59], v34 offset:25408
    s_waitcnt lgkmcnt(4)
    v_mfma_f32_16x16x32_bf16 v[204:207], v[72:75], a[28:31], v[204:207]
    ds_read_b64_tr_b16 v[60:61], v43 offset:24576
    ds_read_b64_tr_b16 v[62:63], v43 offset:25344
    s_waitcnt lgkmcnt(4)
    v_mfma_f32_32x32x16_bf16 v[172:187], v[52:55], a[32:35], v[172:187]
    ds_read_b64_tr_b16 v[64:65], v34 offset:27648
    ds_read_b64_tr_b16 v[66:67], v34 offset:28416
    s_add_u32 s63, s62, 0
    s_mov_b64 exec, s[54:55]
    buffer_store_dwordx4 v[102:105], v46, s[24:27], s63 offen offset:576 sc1
    s_mov_b64 exec, -1
    s_waitcnt lgkmcnt(4)
    v_mfma_f32_32x32x16_bf16 v[188:203], v[56:59], a[32:35], v[188:203]
    ds_read_b64_tr_b16 v[68:69], v34 offset:27712
    ds_read_b64_tr_b16 v[70:71], v34 offset:28480
    s_waitcnt lgkmcnt(4)
    v_mfma_f32_16x16x32_bf16 v[204:207], v[60:63], a[32:35], v[204:207]
    ds_read_b64_tr_b16 v[72:73], v43 offset:27648
    ds_read_b64_tr_b16 v[74:75], v43 offset:28416
    s_waitcnt lgkmcnt(4)
    v_mfma_f32_32x32x16_bf16 v[172:187], v[64:67], a[36:39], v[172:187]
    ds_read_b64_tr_b16 v[52:53], v34 offset:30720
    ds_read_b64_tr_b16 v[54:55], v34 offset:31488
    s_add_u32 s63, s62, 9216
    buffer_store_dwordx4 v[106:109], v44, s[24:27], s63 offen sc1
    s_waitcnt lgkmcnt(4)
    v_mfma_f32_32x32x16_bf16 v[188:203], v[68:71], a[36:39], v[188:203]
    ds_read_b64_tr_b16 v[56:57], v34 offset:30784
    ds_read_b64_tr_b16 v[58:59], v34 offset:31552
    s_waitcnt lgkmcnt(4)
    v_mfma_f32_16x16x32_bf16 v[204:207], v[72:75], a[36:39], v[204:207]
    ds_read_b64_tr_b16 v[60:61], v43 offset:30720
    ds_read_b64_tr_b16 v[62:63], v43 offset:31488
    s_waitcnt lgkmcnt(4)
    v_mfma_f32_32x32x16_bf16 v[172:187], v[52:55], a[40:43], v[172:187]
    ds_read_b64_tr_b16 v[64:65], v34 offset:33792
    ds_read_b64_tr_b16 v[66:67], v34 offset:34560
    s_add_u32 s63, s62, 9216
    s_mov_b64 exec, s[56:57]
    buffer_store_dword v110, v45, s[24:27], s63 offen sc1
    s_mov_b64 exec, -1
    s_waitcnt lgkmcnt(4)
    v_mfma_f32_32x32x16_bf16 v[188:203], v[56:59], a[40:43], v[188:203]
    ds_read_b64_tr_b16 v[68:69], v34 offset:33856
    ds_read_b64_tr_b16 v[70:71], v34 offset:34624
    v_mov_b32 v91, 0x3f803f80
    v_mov_b32 v97, v91
    v_mov_b32 v111, v91
    v_mov_b32 v125, v91
    s_waitcnt lgkmcnt(4)
    v_mfma_f32_16x16x32_bf16 v[204:207], v[60:63], a[40:43], v[204:207]
    ds_read_b64_tr_b16 v[72:73], v43 offset:33792
    ds_read_b64_tr_b16 v[74:75], v43 offset:34560
    v_mov_b32 v139, v91
    s_waitcnt vmcnt(21)
    s_barrier
    v_add_u32 v34, 36864, v34
    v_add_u32 v43, 36864, v43
    s_waitcnt lgkmcnt(4)
    v_mfma_f32_32x32x16_bf16 v[172:187], v[64:67], a[44:47], v[172:187]
    ds_read_b64_tr_b16 v[52:53], v34 offset:0
    ds_read_b64_tr_b16 v[54:55], v34 offset:768
    s_add_u32 s63, s62, 9216
    s_mov_b64 exec, s[54:55]
    buffer_store_dwordx4 v[112:115], v46, s[24:27], s63 offen offset:0 sc1
    s_mov_b64 exec, -1
    s_waitcnt lgkmcnt(4)
    v_mfma_f32_32x32x16_bf16 v[188:203], v[68:71], a[44:47], v[188:203]
    ds_read_b64_tr_b16 v[56:57], v34 offset:64
    ds_read_b64_tr_b16 v[58:59], v34 offset:832
    s_waitcnt lgkmcnt(4)
    v_mfma_f32_16x16x32_bf16 v[204:207], v[72:75], a[44:47], v[204:207]
    ds_read_b64_tr_b16 v[60:61], v43 offset:0
    ds_read_b64_tr_b16 v[62:63], v43 offset:768
    s_waitcnt lgkmcnt(4)
    v_mfma_f32_32x32x16_bf16 v[172:187], v[52:55], a[48:51], v[172:187]
    ds_read_b64_tr_b16 v[64:65], v34 offset:3072
    ds_read_b64_tr_b16 v[66:67], v34 offset:3840
    s_add_u32 s63, s62, 9216
    s_mov_b64 exec, s[54:55]
    buffer_store_dwordx4 v[116:119], v46, s[24:27], s63 offen offset:576 sc1
    s_mov_b64 exec, -1
    s_waitcnt lgkmcnt(4)
    v_mfma_f32_32x32x16_bf16 v[188:203], v[56:59], a[48:51], v[188:203]
    ds_read_b64_tr_b16 v[68:69], v34 offset:3136
    ds_read_b64_tr_b16 v[70:71], v34 offset:3904
    s_waitcnt lgkmcnt(4)
    v_mfma_f32_16x16x32_bf16 v[204:207], v[60:63], a[48:51], v[204:207]
    ds_read_b64_tr_b16 v[72:73], v43 offset:3072
    ds_read_b64_tr_b16 v[74:75], v43 offset:3840
    s_waitcnt lgkmcnt(4)
    v_mfma_f32_32x32x16_bf16 v[172:187], v[64:67], a[52:55], v[172:187]
    ds_read_b64_tr_b16 v[52:53], v34 offset:6144
    ds_read_b64_tr_b16 v[54:55], v34 offset:6912
    s_waitcnt lgkmcnt(4)
    v_mfma_f32_32x32x16_bf16 v[188:203], v[68:71], a[52:55], v[188:203]
    ds_read_b64_tr_b16 v[56:57], v34 offset:6208
    ds_read_b64_tr_b16 v[58:59], v34 offset:6976
    s_waitcnt lgkmcnt(4)
    v_mfma_f32_16x16x32_bf16 v[204:207], v[72:75], a[52:55], v[204:207]
    ds_read_b64_tr_b16 v[60:61], v43 offset:6144
    ds_read_b64_tr_b16 v[62:63], v43 offset:6912
    s_waitcnt lgkmcnt(4)
    v_mfma_f32_32x32x16_bf16 v[172:187], v[52:55], a[56:59], v[172:187]
    ds_read_b64_tr_b16 v[64:65], v34 offset:9216
    ds_read_b64_tr_b16 v[66:67], v34 offset:9984
    s_add_u32 s63, s62, 18432
    buffer_store_dwordx4 v[120:123], v44, s[24:27], s63 offen sc1
    s_waitcnt lgkmcnt(4)
    v_mfma_f32_32x32x16_bf16 v[188:203], v[56:59], a[56:59], v[188:203]
    ds_read_b64_tr_b16 v[68:69], v34 offset:9280
    ds_read_b64_tr_b16 v[70:71], v34 offset:10048
    s_waitcnt lgkmcnt(4)
    v_mfma_f32_16x16x32_bf16 v[204:207], v[60:63], a[56:59], v[204:207]
    ds_read_b64_tr_b16 v[72:73], v43 offset:9216
    ds_read_b64_tr_b16 v[74:75], v43 offset:9984
    s_waitcnt vmcnt(21)
    s_barrier
    s_waitcnt lgkmcnt(4)
    v_mfma_f32_32x32x16_bf16 v[172:187], v[64:67], a[60:63], v[172:187]
    ds_read_b64_tr_b16 v[52:53], v34 offset:12288
    ds_read_b64_tr_b16 v[54:55], v34 offset:13056
    s_waitcnt lgkmcnt(4)
    v_mfma_f32_32x32x16_bf16 v[188:203], v[68:71], a[60:63], v[188:203]
    ds_read_b64_tr_b16 v[56:57], v34 offset:12352
    ds_read_b64_tr_b16 v[58:59], v34 offset:13120
    s_waitcnt lgkmcnt(4)
    v_mfma_f32_16x16x32_bf16 v[204:207], v[72:75], a[60:63], v[204:207]
    ds_read_b64_tr_b16 v[60:61], v43 offset:12288
    ds_read_b64_tr_b16 v[62:63], v43 offset:13056
    s_waitcnt lgkmcnt(4)
    v_mfma_f32_32x32x16_bf16 v[172:187], v[52:55], a[64:67], v[172:187]
    ds_read_b64_tr_b16 v[64:65], v34 offset:15360
    ds_read_b64_tr_b16 v[66:67], v34 offset:16128
    s_add_u32 s63, s62, 18432
    s_mov_b64 exec, s[56:57]
    buffer_store_dword v124, v45, s[24:27], s63 offen sc1
    s_mov_b64 exec, -1
    s_waitcnt lgkmcnt(4)
    v_mfma_f32_32x32x16_bf16 v[188:203], v[56:59], a[64:67], v[188:203]
    ds_read_b64_tr_b16 v[68:69], v34 offset:15424
    ds_read_b64_tr_b16 v[70:71], v34 offset:16192
    s_waitcnt lgkmcnt(4)
    v_mfma_f32_16x16x32_bf16 v[204:207], v[60:63], a[64:67], v[204:207]
    ds_read_b64_tr_b16 v[72:73], v43 offset:15360
    ds_read_b64_tr_b16 v[74:75], v43 offset:16128
    s_waitcnt lgkmcnt(4)
    v_mfma_f32_32x32x16_bf16 v[172:187], v[64:67], a[68:71], v[172:187]
    ds_read_b64_tr_b16 v[52:53], v34 offset:18432
    ds_read_b64_tr_b16 v[54:55], v34 offset:19200
    s_waitcnt lgkmcnt(4)
    v_mfma_f32_32x32x16_bf16 v[188:203], v[68:71], a[68:71], v[188:203]
    ds_read_b64_tr_b16 v[56:57], v34 offset:18496
    ds_read_b64_tr_b16 v[58:59], v34 offset:19264
    s_waitcnt lgkmcnt(4)
    v_mfma_f32_16x16x32_bf16 v[204:207], v[72:75], a[68:71], v[204:207]
    ds_read_b64_tr_b16 v[60:61], v43 offset:18432
    ds_read_b64_tr_b16 v[62:63], v43 offset:19200
    s_waitcnt lgkmcnt(4)
    v_mfma_f32_32x32x16_bf16 v[172:187], v[52:55], a[72:75], v[172:187]
    ds_read_b64_tr_b16 v[64:65], v34 offset:21504
    ds_read_b64_tr_b16 v[66:67], v34 offset:22272
    s_add_u32 s63, s62, 18432
    s_mov_b64 exec, s[54:55]
    buffer_store_dwordx4 v[126:129], v46, s[24:27], s63 offen offset:0 sc1
    s_mov_b64 exec, -1
    s_waitcnt lgkmcnt(4)
    v_mfma_f32_32x32x16_bf16 v[188:203], v[56:59], a[72:75], v[188:203]
    ds_read_b64_tr_b16 v[68:69], v34 offset:21568
    ds_read_b64_tr_b16 v[70:71], v34 offset:22336
    s_waitcnt lgkmcnt(4)
    v_mfma_f32_16x16x32_bf16 v[204:207], v[60:63], a[72:75], v[204:207]
    ds_read_b64_tr_b16 v[72:73], v43 offset:21504
    ds_read_b64_tr_b16 v[74:75], v43 offset:22272
    s_waitcnt vmcnt(20)
    s_barrier
    s_waitcnt lgkmcnt(4)
    v_mfma_f32_32x32x16_bf16 v[172:187], v[64:67], a[76:79], v[172:187]
    ds_read_b64_tr_b16 v[52:53], v34 offset:24576
    ds_read_b64_tr_b16 v[54:55], v34 offset:25344
    s_waitcnt lgkmcnt(4)
    v_mfma_f32_32x32x16_bf16 v[188:203], v[68:71], a[76:79], v[188:203]
    ds_read_b64_tr_b16 v[56:57], v34 offset:24640
    ds_read_b64_tr_b16 v[58:59], v34 offset:25408
    s_waitcnt lgkmcnt(4)
    v_mfma_f32_16x16x32_bf16 v[204:207], v[72:75], a[76:79], v[204:207]
    ds_read_b64_tr_b16 v[60:61], v43 offset:24576
    ds_read_b64_tr_b16 v[62:63], v43 offset:25344
    s_waitcnt lgkmcnt(4)
    v_mfma_f32_32x32x16_bf16 v[172:187], v[52:55], a[80:83], v[172:187]
    ds_read_b64_tr_b16 v[64:65], v34 offset:27648
    ds_read_b64_tr_b16 v[66:67], v34 offset:28416
    s_add_u32 s63, s62, 18432
    s_mov_b64 exec, s[54:55]
    buffer_store_dwordx4 v[130:133], v46, s[24:27], s63 offen offset:576 sc1
    s_mov_b64 exec, -1
    s_waitcnt lgkmcnt(4)
    v_mfma_f32_32x32x16_bf16 v[188:203], v[56:59], a[80:83], v[188:203]
    ds_read_b64_tr_b16 v[68:69], v34 offset:27712
    ds_read_b64_tr_b16 v[70:71], v34 offset:28480
    s_waitcnt lgkmcnt(4)
    v_mfma_f32_16x16x32_bf16 v[204:207], v[60:63], a[80:83], v[204:207]
    ds_read_b64_tr_b16 v[72:73], v43 offset:27648
    ds_read_b64_tr_b16 v[74:75], v43 offset:28416
    s_waitcnt lgkmcnt(4)
    v_mfma_f32_32x32x16_bf16 v[172:187], v[64:67], a[84:87], v[172:187]
    ds_read_b64_tr_b16 v[52:53], v34 offset:30720
    ds_read_b64_tr_b16 v[54:55], v34 offset:31488
    s_waitcnt lgkmcnt(4)
    v_mfma_f32_32x32x16_bf16 v[188:203], v[68:71], a[84:87], v[188:203]
    ds_read_b64_tr_b16 v[56:57], v34 offset:30784
    ds_read_b64_tr_b16 v[58:59], v34 offset:31552
    s_waitcnt lgkmcnt(4)
    v_mfma_f32_16x16x32_bf16 v[204:207], v[72:75], a[84:87], v[204:207]
    ds_read_b64_tr_b16 v[60:61], v43 offset:30720
    ds_read_b64_tr_b16 v[62:63], v43 offset:31488
    s_waitcnt lgkmcnt(4)
    v_mfma_f32_32x32x16_bf16 v[172:187], v[52:55], a[88:91], v[172:187]
    ds_read_b64_tr_b16 v[64:65], v34 offset:33792
    ds_read_b64_tr_b16 v[66:67], v34 offset:34560
    s_add_u32 s63, s62, 27648
    buffer_store_dwordx4 v[134:137], v44, s[24:27], s63 offen sc1
    s_waitcnt lgkmcnt(4)
    v_mfma_f32_32x32x16_bf16 v[188:203], v[56:59], a[88:91], v[188:203]
    ds_read_b64_tr_b16 v[68:69], v34 offset:33856
    ds_read_b64_tr_b16 v[70:71], v34 offset:34624
    s_waitcnt lgkmcnt(4)
    v_mfma_f32_16x16x32_bf16 v[204:207], v[60:63], a[88:91], v[204:207]
    ds_read_b64_tr_b16 v[72:73], v43 offset:33792
    ds_read_b64_tr_b16 v[74:75], v43 offset:34560
    s_waitcnt vmcnt(19)
    s_barrier
    v_add_u32 v34, 36864, v34
    v_add_u32 v43, 36864, v43
    s_waitcnt lgkmcnt(4)
    v_mfma_f32_32x32x16_bf16 v[172:187], v[64:67], a[92:95], v[172:187]
    ds_read_b64_tr_b16 v[52:53], v34 offset:0
    ds_read_b64_tr_b16 v[54:55], v34 offset:768
    s_waitcnt lgkmcnt(4)
    v_mfma_f32_32x32x16_bf16 v[188:203], v[68:71], a[92:95], v[188:203]
    ds_read_b64_tr_b16 v[56:57], v34 offset:64
    ds_read_b64_tr_b16 v[58:59], v34 offset:832
    s_waitcnt lgkmcnt(4)
    v_mfma_f32_16x16x32_bf16 v[204:207], v[72:75], a[92:95], v[204:207]
    ds_read_b64_tr_b16 v[60:61], v43 offset:0
    ds_read_b64_tr_b16 v[62:63], v43 offset:768
    s_waitcnt vmcnt(5)
    v_readfirstlane_b32 s68, v48
    v_readfirstlane_b32 s69, v49
    s_nop 1
    s_or_b32 s63, s68, s69
    s_cmp_lg_u32 s63, 0
    s_cbranch_scc1 L_have_nonce
    s_mov_b32 s76, 100000
L_nonce_poll:
    v_mov_b32 v51, 0
    buffer_load_dwordx2 v[48:49], v51, s[28:31], 0 offen sc1
    s_waitcnt vmcnt(0)
    v_readfirstlane_b32 s68, v48
    v_readfirstlane_b32 s69, v49
    s_nop 1
    s_or_b32 s63, s68, s69
    s_cmp_lg_u32 s63, 0
    s_cbranch_scc1 L_have_nonce
    s_sub_u32 s76, s76, 1
    s_cmp_lg_u32 s76, 0
    s_cbranch_scc1 L_nonce_poll
L_have_nonce:
    s_add_u32 s64, s69, 2
    v_mov_b32 v2, s68
    v_mov_b32 v3, s64
    v_mov_b32 v4, 0
    s_mov_b64 exec, 1
    buffer_store_dwordx2 v[2:3], v4, s[24:27], s66 offen sc1
    s_mov_b64 exec, -1
    s_waitcnt lgkmcnt(4)
    v_mfma_f32_32x32x16_bf16 v[172:187], v[52:55], a[96:99], v[172:187]
    ds_read_b64_tr_b16 v[64:65], v34 offset:3072
    ds_read_b64_tr_b16 v[66:67], v34 offset:3840
    s_add_u32 s63, s62, 27648
    s_mov_b64 exec, s[56:57]
    buffer_store_dword v138, v45, s[24:27], s63 offen sc1
    s_mov_b64 exec, -1
    s_waitcnt lgkmcnt(4)
    v_mfma_f32_32x32x16_bf16 v[188:203], v[56:59], a[96:99], v[188:203]
    ds_read_b64_tr_b16 v[68:69], v34 offset:3136
    ds_read_b64_tr_b16 v[70:71], v34 offset:3904
    s_waitcnt lgkmcnt(4)
    v_mfma_f32_16x16x32_bf16 v[204:207], v[60:63], a[96:99], v[204:207]
    ds_read_b64_tr_b16 v[72:73], v43 offset:3072
    ds_read_b64_tr_b16 v[74:75], v43 offset:3840
    s_waitcnt lgkmcnt(4)
    v_mfma_f32_32x32x16_bf16 v[172:187], v[64:67], a[100:103], v[172:187]
    ds_read_b64_tr_b16 v[52:53], v34 offset:6144
    ds_read_b64_tr_b16 v[54:55], v34 offset:6912
    s_waitcnt lgkmcnt(4)
    v_mfma_f32_32x32x16_bf16 v[188:203], v[68:71], a[100:103], v[188:203]
    ds_read_b64_tr_b16 v[56:57], v34 offset:6208
    ds_read_b64_tr_b16 v[58:59], v34 offset:6976
    s_waitcnt lgkmcnt(4)
    v_mfma_f32_16x16x32_bf16 v[204:207], v[72:75], a[100:103], v[204:207]
    ds_read_b64_tr_b16 v[60:61], v43 offset:6144
    ds_read_b64_tr_b16 v[62:63], v43 offset:6912
    s_waitcnt lgkmcnt(4)
    v_mfma_f32_32x32x16_bf16 v[172:187], v[52:55], a[104:107], v[172:187]
    ds_read_b64_tr_b16 v[64:65], v34 offset:9216
    ds_read_b64_tr_b16 v[66:67], v34 offset:9984
    s_add_u32 s63, s62, 27648
    s_mov_b64 exec, s[54:55]
    buffer_store_dwordx4 v[140:143], v46, s[24:27], s63 offen offset:0 sc1
    s_mov_b64 exec, -1
    s_waitcnt lgkmcnt(4)
    v_mfma_f32_32x32x16_bf16 v[188:203], v[56:59], a[104:107], v[188:203]
    ds_read_b64_tr_b16 v[68:69], v34 offset:9280
    ds_read_b64_tr_b16 v[70:71], v34 offset:10048
    s_waitcnt lgkmcnt(4)
    v_mfma_f32_16x16x32_bf16 v[204:207], v[60:63], a[104:107], v[204:207]
    ds_read_b64_tr_b16 v[72:73], v43 offset:9216
    ds_read_b64_tr_b16 v[74:75], v43 offset:9984
    s_waitcnt vmcnt(19)
    s_barrier
    s_waitcnt lgkmcnt(4)
    v_mfma_f32_32x32x16_bf16 v[172:187], v[64:67], a[108:111], v[172:187]
    ds_read_b64_tr_b16 v[52:53], v34 offset:12288
    ds_read_b64_tr_b16 v[54:55], v34 offset:13056
    s_waitcnt lgkmcnt(4)
    v_mfma_f32_32x32x16_bf16 v[188:203], v[68:71], a[108:111], v[188:203]
    ds_read_b64_tr_b16 v[56:57], v34 offset:12352
    ds_read_b64_tr_b16 v[58:59], v34 offset:13120
    s_waitcnt lgkmcnt(4)
    v_mfma_f32_16x16x32_bf16 v[204:207], v[72:75], a[108:111], v[204:207]
    ds_read_b64_tr_b16 v[60:61], v43 offset:12288
    ds_read_b64_tr_b16 v[62:63], v43 offset:13056
    s_waitcnt lgkmcnt(4)
    v_mfma_f32_32x32x16_bf16 v[172:187], v[52:55], a[112:115], v[172:187]
    ds_read_b64_tr_b16 v[64:65], v34 offset:15360
    ds_read_b64_tr_b16 v[66:67], v34 offset:16128
    s_add_u32 s63, s62, 27648
    s_mov_b64 exec, s[54:55]
    buffer_store_dwordx4 v[144:147], v46, s[24:27], s63 offen offset:576 sc1
    s_mov_b64 exec, -1
    s_waitcnt lgkmcnt(4)
    v_mfma_f32_32x32x16_bf16 v[188:203], v[56:59], a[112:115], v[188:203]
    ds_read_b64_tr_b16 v[68:69], v34 offset:15424
    ds_read_b64_tr_b16 v[70:71], v34 offset:16192
    s_waitcnt lgkmcnt(4)
    v_mfma_f32_16x16x32_bf16 v[204:207], v[60:63], a[112:115], v[204:207]
    ds_read_b64_tr_b16 v[72:73], v43 offset:15360
    ds_read_b64_tr_b16 v[74:75], v43 offset:16128
    s_waitcnt lgkmcnt(4)
    v_mfma_f32_32x32x16_bf16 v[172:187], v[64:67], a[116:119], v[172:187]
    ds_read_b64_tr_b16 v[52:53], v34 offset:18432
    ds_read_b64_tr_b16 v[54:55], v34 offset:19200
    s_waitcnt lgkmcnt(4)
    v_mfma_f32_32x32x16_bf16 v[188:203], v[68:71], a[116:119], v[188:203]
    ds_read_b64_tr_b16 v[56:57], v34 offset:18496
    ds_read_b64_tr_b16 v[58:59], v34 offset:19264
    s_waitcnt lgkmcnt(4)
    v_mfma_f32_16x16x32_bf16 v[204:207], v[72:75], a[116:119], v[204:207]
    ds_read_b64_tr_b16 v[60:61], v43 offset:18432
    ds_read_b64_tr_b16 v[62:63], v43 offset:19200
    s_waitcnt lgkmcnt(4)
    v_mfma_f32_32x32x16_bf16 v[172:187], v[52:55], a[120:123], v[172:187]
    ds_read_b64_tr_b16 v[64:65], v34 offset:21504
    ds_read_b64_tr_b16 v[66:67], v34 offset:22272
    s_waitcnt lgkmcnt(4)
    v_mfma_f32_32x32x16_bf16 v[188:203], v[56:59], a[120:123], v[188:203]
    ds_read_b64_tr_b16 v[68:69], v34 offset:21568
    ds_read_b64_tr_b16 v[70:71], v34 offset:22336
    s_waitcnt lgkmcnt(4)
    v_mfma_f32_16x16x32_bf16 v[204:207], v[60:63], a[120:123], v[204:207]
    ds_read_b64_tr_b16 v[72:73], v43 offset:21504
    ds_read_b64_tr_b16 v[74:75], v43 offset:22272
    s_waitcnt vmcnt(17)
    s_barrier
    s_waitcnt lgkmcnt(4)
    v_mfma_f32_32x32x16_bf16 v[172:187], v[64:67], a[124:127], v[172:187]
    ds_read_b64_tr_b16 v[52:53], v34 offset:24576
    ds_read_b64_tr_b16 v[54:55], v34 offset:25344
    s_waitcnt lgkmcnt(4)
    v_mfma_f32_32x32x16_bf16 v[188:203], v[68:71], a[124:127], v[188:203]
    ds_read_b64_tr_b16 v[56:57], v34 offset:24640
    ds_read_b64_tr_b16 v[58:59], v34 offset:25408
    s_waitcnt lgkmcnt(4)
    v_mfma_f32_16x16x32_bf16 v[204:207], v[72:75], a[124:127], v[204:207]
    ds_read_b64_tr_b16 v[60:61], v43 offset:24576
    ds_read_b64_tr_b16 v[62:63], v43 offset:25344
    s_waitcnt lgkmcnt(4)
    v_mfma_f32_32x32x16_bf16 v[172:187], v[52:55], a[128:131], v[172:187]
    ds_read_b64_tr_b16 v[64:65], v34 offset:27648
    ds_read_b64_tr_b16 v[66:67], v34 offset:28416
    s_waitcnt lgkmcnt(4)
    v_mfma_f32_32x32x16_bf16 v[188:203], v[56:59], a[128:131], v[188:203]
    ds_read_b64_tr_b16 v[68:69], v34 offset:27712
    ds_read_b64_tr_b16 v[70:71], v34 offset:28480
    s_waitcnt lgkmcnt(4)
    v_mfma_f32_16x16x32_bf16 v[204:207], v[60:63], a[128:131], v[204:207]
    ds_read_b64_tr_b16 v[72:73], v43 offset:27648
    ds_read_b64_tr_b16 v[74:75], v43 offset:28416
    s_waitcnt lgkmcnt(4)
    v_mfma_f32_32x32x16_bf16 v[172:187], v[64:67], a[132:135], v[172:187]
    ds_read_b64_tr_b16 v[52:53], v34 offset:30720
    ds_read_b64_tr_b16 v[54:55], v34 offset:31488
    s_waitcnt lgkmcnt(4)
    v_mfma_f32_32x32x16_bf16 v[188:203], v[68:71], a[132:135], v[188:203]
    ds_read_b64_tr_b16 v[56:57], v34 offset:30784
    ds_read_b64_tr_b16 v[58:59], v34 offset:31552
    s_waitcnt lgkmcnt(4)
    v_mfma_f32_16x16x32_bf16 v[204:207], v[72:75], a[132:135], v[204:207]
    ds_read_b64_tr_b16 v[60:61], v43 offset:30720
    ds_read_b64_tr_b16 v[62:63], v43 offset:31488
    s_waitcnt lgkmcnt(4)
    v_mfma_f32_32x32x16_bf16 v[172:187], v[52:55], a[136:139], v[172:187]
    ds_read_b64_tr_b16 v[64:65], v34 offset:33792
    ds_read_b64_tr_b16 v[66:67], v34 offset:34560
    s_waitcnt lgkmcnt(4)
    v_mfma_f32_32x32x16_bf16 v[188:203], v[56:59], a[136:139], v[188:203]
    ds_read_b64_tr_b16 v[68:69], v34 offset:33856
    ds_read_b64_tr_b16 v[70:71], v34 offset:34624
    s_waitcnt lgkmcnt(4)
    v_mfma_f32_16x16x32_bf16 v[204:207], v[60:63], a[136:139], v[204:207]
    ds_read_b64_tr_b16 v[72:73], v43 offset:33792
    ds_read_b64_tr_b16 v[74:75], v43 offset:34560
    s_waitcnt lgkmcnt(4)
    v_mfma_f32_32x32x16_bf16 v[172:187], v[64:67], a[140:143], v[172:187]
    s_waitcnt lgkmcnt(2)
    v_mfma_f32_32x32x16_bf16 v[188:203], v[68:71], a[140:143], v[188:203]
    s_waitcnt lgkmcnt(0)
    v_mfma_f32_16x16x32_bf16 v[204:207], v[72:75], a[140:143], v[204:207]
    s_cmp_ge_u32 s33, 2
    s_cselect_b32 s64, 2, 1
    s_lshl_b32 s64, s64, 9
    s_sub_u32 s63, s66, 512
    s_sub_u32 s64, s66, s64
    s_cmp_eq_u32 s33, 0
    s_cselect_b32 s63, s66, s63
    s_cselect_b32 s64, s66, s64
    v_mov_b32 v8, s63
    v_mov_b32 v9, s64
    v_cmp_eq_u32 vcc, 0, v1
    s_nop 1
    v_cndmask_b32 v5, v9, v8, vcc
    s_mov_b64 exec, 3
    buffer_load_dwordx2 v[6:7], v5, s[24:27], 0 offen sc1
    s_mov_b64 exec, -1
    s_nop 13
    v_mov_b32 v90, s80
    v_mov_b32 v91, s80
    v_pk_mul_f32 v[172:173], v[90:91], v[172:173]
    v_pk_mul_f32 v[174:175], v[90:91], v[174:175]
    v_pk_mul_f32 v[176:177], v[90:91], v[176:177]
    v_pk_mul_f32 v[178:179], v[90:91], v[178:179]
    v_pk_mul_f32 v[180:181], v[90:91], v[180:181]
    v_pk_mul_f32 v[182:183], v[90:91], v[182:183]
    v_pk_mul_f32 v[184:185], v[90:91], v[184:185]
    v_pk_mul_f32 v[186:187], v[90:91], v[186:187]
    v_pk_mul_f32 v[188:189], v[90:91], v[188:189]
    v_pk_mul_f32 v[190:191], v[90:91], v[190:191]
    v_pk_mul_f32 v[192:193], v[90:91], v[192:193]
    v_pk_mul_f32 v[194:195], v[90:91], v[194:195]
    v_pk_mul_f32 v[196:197], v[90:91], v[196:197]
    v_pk_mul_f32 v[198:199], v[90:91], v[198:199]
    v_pk_mul_f32 v[200:201], v[90:91], v[200:201]
    v_pk_mul_f32 v[202:203], v[90:91], v[202:203]
    v_pk_mul_f32 v[204:205], v[90:91], v[204:205]
    v_pk_mul_f32 v[206:207], v[90:91], v[206:207]
    v_cvt_pk_bf16_f32 v76, v172, v173
    v_cvt_pk_bf16_f32 v77, v174, v175
    ds_write2_b32 v36, v76, v77 offset0:0 offset1:1
    v_cvt_pk_bf16_f32 v78, v176, v177
    v_cvt_pk_bf16_f32 v79, v178, v179
    ds_write2_b32 v36, v78, v79 offset0:4 offset1:5
    v_cvt_pk_bf16_f32 v80, v180, v181
    v_cvt_pk_bf16_f32 v81, v182, v183
    ds_write2_b32 v36, v80, v81 offset0:8 offset1:9
    v_cvt_pk_bf16_f32 v82, v184, v185
    v_cvt_pk_bf16_f32 v83, v186, v187
    ds_write2_b32 v36, v82, v83 offset0:12 offset1:13
    v_cvt_pk_bf16_f32 v84, v188, v189
    v_cvt_pk_bf16_f32 v85, v190, v191
    ds_write2_b32 v36, v84, v85 offset0:16 offset1:17
    v_cvt_pk_bf16_f32 v86, v192, v193
    v_cvt_pk_bf16_f32 v87, v194, v195
    ds_write2_b32 v36, v86, v87 offset0:20 offset1:21
    v_cvt_pk_bf16_f32 v88, v196, v197
    v_cvt_pk_bf16_f32 v89, v198, v199
    ds_write2_b32 v36, v88, v89 offset0:24 offset1:25
    v_cvt_pk_bf16_f32 v90, v200, v201
    v_cvt_pk_bf16_f32 v91, v202, v203
    ds_write2_b32 v36, v90, v91 offset0:28 offset1:29
    v_cvt_pk_bf16_f32 v76, v204, v205
    v_cvt_pk_bf16_f32 v77, v206, v207
    v_and_b32 v2, 15, v1
    v_lshrrev_b32 v3, 5, v1
    v_lshl_add_u32 v2, v3, 4, v2
    v_mul_u32_u24 v2, 148, v2
    v_bfe_u32 v3, v1, 4, 1
    v_lshl_add_u32 v2, v3, 3, v2
    s_mul_i32 s63, s35, 4736
    s_add_u32 s63, s63, 128
    v_add_u32 v2, s63, v2
    ds_write2_b32 v2, v76, v77 offset0:0 offset1:1
    v_mov_b32 v51, 0
    v_accvgpr_write_b32 a4, v51
    v_accvgpr_write_b32 a5, v51
    v_accvgpr_write_b32 a6, v51
    v_accvgpr_write_b32 a7, v51
    v_accvgpr_write_b32 a12, v51
    v_accvgpr_write_b32 a13, v51
    v_accvgpr_write_b32 a14, v51
    v_accvgpr_write_b32 a15, v51
    v_accvgpr_write_b32 a20, v51
    v_accvgpr_write_b32 a21, v51
    v_accvgpr_write_b32 a22, v51
    v_accvgpr_write_b32 a23, v51
    v_accvgpr_write_b32 a28, v51
    v_accvgpr_write_b32 a29, v51
    v_accvgpr_write_b32 a30, v51
    v_accvgpr_write_b32 a31, v51
    s_waitcnt lgkmcnt(0)
    s_barrier
    v_add_u32 v88, 0, v39
    ds_read2_b32 a[0:1], v88 offset0:0 offset1:1
    ds_read2_b32 a[2:3], v88 offset0:2 offset1:3
    v_add_u32 v88, 4736, v39
    ds_read2_b32 a[8:9], v88 offset0:0 offset1:1
    ds_read2_b32 a[10:11], v88 offset0:2 offset1:3
    v_add_u32 v88, 9472, v39
    ds_read2_b32 a[16:17], v88 offset0:0 offset1:1
    ds_read2_b32 a[18:19], v88 offset0:2 offset1:3
    v_add_u32 v88, 14208, v39
    ds_read2_b32 a[24:25], v88 offset0:0 offset1:1
    ds_read2_b32 a[26:27], v88 offset0:2 offset1:3
    s_mov_b64 exec, s[56:57]
    v_add_u32 v89, 0, v40
    ds_read_b32 a4, v89
    v_add_u32 v89, 4736, v40
    ds_read_b32 a12, v89
    v_add_u32 v89, 9472, v40
    ds_read_b32 a20, v89
    v_add_u32 v89, 14208, v40
    ds_read_b32 a28, v89
    s_mov_b64 exec, -1
    s_waitcnt lgkmcnt(0)
    s_barrier
    s_mov_b32 s52, 0
L_att:
    v_mov_b32 v254, 0x207
    v_mfma_f32_32x32x16_bf16 v[52:67], v[92:95], a[0:3], 0
    v_mfma_f32_32x32x16_bf16 v[52:67], v[96:99], a[4:7], v[52:67]
    s_waitcnt vmcnt(0)
    s_mov_b32 s76, 200000
L_chk0:
    s_cmp_eq_u32 s33, 0
    s_cbranch_scc1 L_ok0
    s_mov_b64 exec, 3
    v_subrev_u32 v8, s69, v7
    v_cmp_eq_u32 vcc, s68, v6
    v_cmp_le_u32 s[4:5], 2, v8
    v_cmp_ge_u32 s[6:7], 4, v8
    s_mov_b64 exec, -1
    s_and_b64 s[4:5], s[4:5], vcc
    s_and_b64 s[4:5], s[4:5], s[6:7]
    s_and_b32 s4, s4, 3
    s_cmp_eq_u32 s4, 3
    s_cbranch_scc1 L_ok0
    s_mov_b64 exec, 3
    buffer_load_dwordx2 v[6:7], v5, s[24:27], 0 offen sc1
    s_mov_b64 exec, -1
    s_waitcnt vmcnt(0)
    s_sub_u32 s76, s76, 1
    s_cmp_lg_u32 s76, 0
    s_cbranch_scc1 L_chk0
L_ok0:
    s_nop 11
    v_mfma_f32_32x32x16_bf16 v[68:83], v[92:95], a[8:11], 0
    v_exp_f32 v52, v52
    v_exp_f32 v53, v53
    v_exp_f32 v54, v54
    v_exp_f32 v55, v55
    s_add_u32 s63, s71, 0
    buffer_load_dwordx4 a[200:203], v44, s[24:27], s63 offen sc1
    buffer_load_dword a204, v45, s[24:27], s63 offen sc1
    s_mov_b64 exec, s[54:55]
    buffer_load_dwordx4 a[206:209], v46, s[24:27], s63 offen sc1
    buffer_load_dwordx4 a[210:213], v46, s[24:27], s63 offen offset:576 sc1
    s_mov_b64 exec, -1
    v_cvt_pk_bf16_f32 v150, v52, v53
    v_cvt_pk_bf16_f32 v151, v54, v55
    v_and_b32 v150, v236, v150
    v_and_b32 v151, v237, v151
    v_mfma_f32_32x32x16_bf16 v[68:83], v[96:99], a[12:15], v[68:83]
    v_exp_f32 v56, v56
    v_exp_f32 v57, v57
    v_exp_f32 v58, v58
    v_exp_f32 v59, v59
    v_cvt_pk_bf16_f32 v152, v56, v57
    v_cvt_pk_bf16_f32 v153, v58, v59
    v_and_b32 v152, v238, v152
    v_and_b32 v153, v239, v153
    v_exp_f32 v60, v60
    v_exp_f32 v61, v61
    v_exp_f32 v62, v62
    v_exp_f32 v63, v63
    s_add_u32 s63, s71, 9216
    buffer_load_dwordx4 a[214:217], v44, s[24:27], s63 offen sc1
    buffer_load_dword a218, v45, s[24:27], s63 offen sc1
    s_mov_b64 exec, s[54:55]
    buffer_load_dwordx4 a[220:223], v46, s[24:27], s63 offen sc1
    buffer_load_dwordx4 a[224:227], v46, s[24:27], s63 offen offset:576 sc1
    s_mov_b64 exec, -1
    v_cvt_pk_bf16_f32 v154, v60, v61
    v_cvt_pk_bf16_f32 v155, v62, v63
    v_and_b32 v154, v240, v154
    v_and_b32 v155, v241, v155
    v_exp_f32 v64, v64
    v_exp_f32 v65, v65
    v_exp_f32 v66, v66
    v_exp_f32 v67, v67
    v_cvt_pk_bf16_f32 v156, v64, v65
    v_cvt_pk_bf16_f32 v157, v66, v67
    v_and_b32 v156, v242, v156
    v_and_b32 v157, v243, v157
    v_mfma_f32_32x32x16_bf16 v[52:67], v[106:109], a[8:11], 0
    v_exp_f32 v68, v68
    v_exp_f32 v69, v69
    v_exp_f32 v70, v70
    v_exp_f32 v71, v71
    s_add_u32 s63, s72, 0
    buffer_load_dwordx4 a[144:147], v44, s[24:27], s63 offen sc1
    buffer_load_dword a148, v45, s[24:27], s63 offen sc1
    s_mov_b64 exec, s[54:55]
    buffer_load_dwordx4 a[150:153], v46, s[24:27], s63 offen sc1
    buffer_load_dwordx4 a[154:157], v46, s[24:27], s63 offen offset:576 sc1
    s_mov_b64 exec, -1
    v_cvt_pk_bf16_f32 v158, v68, v69
    v_cvt_pk_bf16_f32 v159, v70, v71
    v_mfma_f32_32x32x16_bf16 v[52:67], v[110:113], a[12:15], v[52:67]
    v_exp_f32 v72, v72
    v_exp_f32 v73, v73
    v_exp_f32 v74, v74
    v_exp_f32 v75, v75
    v_cvt_pk_bf16_f32 v160, v72, v73
    v_cvt_pk_bf16_f32 v161, v74, v75
    v_mfma_f32_32x32x16_bf16 v[172:187], v[98:101], v[150:153], 0
    v_exp_f32 v76, v76
    v_exp_f32 v77, v77
    v_exp_f32 v78, v78
    v_exp_f32 v79, v79
    s_add_u32 s63, s72, 9216
    buffer_load_dwordx4 a[158:161], v44, s[24:27], s63 offen sc1
    buffer_load_dword a162, v45, s[24:27], s63 offen sc1
    s_mov_b64 exec, s[54:55]
    buffer_load_dwordx4 a[164:167], v46, s[24:27], s63 offen sc1
    buffer_load_dwordx4 a[168:171], v46, s[24:27], s63 offen offset:576 sc1
    s_mov_b64 exec, -1
    v_cvt_pk_bf16_f32 v162, v76, v77
    v_cvt_pk_bf16_f32 v163, v78, v79
    v_mfma_f32_32x32x16_bf16 v[172:187], v[102:105], v[154:157], v[172:187]
    v_exp_f32 v80, v80
    v_exp_f32 v81, v81
    v_exp_f32 v82, v82
    v_exp_f32 v83, v83
    v_cvt_pk_bf16_f32 v164, v80, v81
    v_cvt_pk_bf16_f32 v165, v82, v83
    v_mfma_f32_32x32x16_bf16 v[68:83], v[92:95], a[16:19], 0
    v_exp_f32 v52, v52
    v_exp_f32 v53, v53
    v_exp_f32 v54, v54
    v_exp_f32 v55, v55
    v_cvt_pk_bf16_f32 v150, v52, v53
    v_cvt_pk_bf16_f32 v151, v54, v55
    v_and_b32 v150, v236, v150
    v_and_b32 v151, v237, v151
    v_mfma_f32_32x32x16_bf16 v[68:83], v[96:99], a[20:23], v[68:83]
    v_exp_f32 v56, v56
    v_exp_f32 v57, v57
    v_exp_f32 v58, v58
    v_exp_f32 v59, v59
    v_cvt_pk_bf16_f32 v152, v56, v57
    v_cvt_pk_bf16_f32 v153, v58, v59
    v_and_b32 v152, v238, v152
    v_and_b32 v153, v239, v153
    v_mfma_f32_32x32x16_bf16 v[188:203], v[98:101], v[158:161], 0
    v_exp_f32 v60, v60
    v_exp_f32 v61, v61
    v_exp_f32 v62, v62
    v_exp_f32 v63, v63
    v_cvt_pk_bf16_f32 v154, v60, v61
    v_cvt_pk_bf16_f32 v155, v62, v63
    v_and_b32 v154, v240, v154
    v_and_b32 v155, v241, v155
    v_mfma_f32_32x32x16_bf16 v[188:203], v[102:105], v[162:165], v[188:203]
    v_exp_f32 v64, v64
    v_exp_f32 v65, v65
    v_exp_f32 v66, v66
    v_exp_f32 v67, v67
    s_waitcnt vmcnt(17)
    s_add_u32 s64, s69, 4
    v_mov_b32 v2, s68
    v_mov_b32 v3, s64
    v_mov_b32 v4, 0
    s_mov_b64 exec, 1
    buffer_store_dwordx2 v[2:3], v4, s[24:27], s66 offen sc1
    s_mov_b64 exec, -1
    v_cvt_pk_bf16_f32 v156, v64, v65
    v_cvt_pk_bf16_f32 v157, v66, v67
    v_and_b32 v156, v242, v156
    v_and_b32 v157, v243, v157
    v_mfma_f32_32x32x16_bf16 v[52:67], v[106:109], a[16:19], 0
    v_exp_f32 v68, v68
    v_exp_f32 v69, v69
    v_exp_f32 v70, v70
    v_exp_f32 v71, v71
    v_cvt_pk_bf16_f32 v158, v68, v69
    v_cvt_pk_bf16_f32 v159, v70, v71
    v_mfma_f32_32x32x16_bf16 v[52:67], v[110:113], a[20:23], v[52:67]
    v_exp_f32 v72, v72
    v_exp_f32 v73, v73
    v_exp_f32 v74, v74
    v_exp_f32 v75, v75
    v_cvt_pk_bf16_f32 v160, v72, v73
    v_cvt_pk_bf16_f32 v161, v74, v75
    v_mfma_f32_32x32x16_bf16 v[188:203], v[112:115], v[150:153], v[188:203]
    v_exp_f32 v76, v76
    v_exp_f32 v77, v77
    v_exp_f32 v78, v78
    v_exp_f32 v79, v79
    v_cvt_pk_bf16_f32 v162, v76, v77
    v_cvt_pk_bf16_f32 v163, v78, v79
    v_mfma_f32_32x32x16_bf16 v[188:203], v[116:119], v[154:157], v[188:203]
    v_exp_f32 v80, v80
    v_exp_f32 v81, v81
    v_exp_f32 v82, v82
    v_exp_f32 v83, v83
    v_cvt_pk_bf16_f32 v164, v80, v81
    v_cvt_pk_bf16_f32 v165, v82, v83
    v_mfma_f32_32x32x16_bf16 v[68:83], v[120:123], a[16:19], 0
    v_exp_f32 v52, v52
    v_exp_f32 v53, v53
    v_exp_f32 v54, v54
    v_exp_f32 v55, v55
    v_cvt_pk_bf16_f32 v150, v52, v53
    v_cvt_pk_bf16_f32 v151, v54, v55
    v_mfma_f32_32x32x16_bf16 v[68:83], v[124:127], a[20:23], v[68:83]
    v_exp_f32 v56, v56
    v_exp_f32 v57, v57
    v_exp_f32 v58, v58
    v_exp_f32 v59, v59
    v_cvt_pk_bf16_f32 v152, v56, v57
    v_cvt_pk_bf16_f32 v153, v58, v59
    v_mfma_f32_32x32x16_bf16 v[204:219], v[98:101], v[158:161], 0
    v_exp_f32 v60, v60
    v_exp_f32 v61, v61
    v_exp_f32 v62, v62
    v_exp_f32 v63, v63
    v_cvt_pk_bf16_f32 v154, v60, v61
    v_cvt_pk_bf16_f32 v155, v62, v63
    v_mfma_f32_32x32x16_bf16 v[204:219], v[102:105], v[162:165], v[204:219]
    v_exp_f32 v64, v64
    v_exp_f32 v65, v65
    v_exp_f32 v66, v66
    v_exp_f32 v67, v67
    v_cvt_pk_bf16_f32 v156, v64, v65
    v_cvt_pk_bf16_f32 v157, v66, v67
    v_mfma_f32_32x32x16_bf16 v[52:67], v[92:95], a[24:27], 0
    v_exp_f32 v68, v68
    v_exp_f32 v69, v69
    v_exp_f32 v70, v70
    v_exp_f32 v71, v71
    v_cvt_pk_bf16_f32 v158, v68, v69
    v_cvt_pk_bf16_f32 v159, v70, v71
    v_and_b32 v158, v236, v158
    v_and_b32 v159, v237, v159
    v_mfma_f32_32x32x16_bf16 v[52:67], v[96:99], a[28:31], v[52:67]
    v_exp_f32 v72, v72
    v_exp_f32 v73, v73
    v_exp_f32 v74, v74
    v_exp_f32 v75, v75
    v_cvt_pk_bf16_f32 v160, v72, v73
    v_cvt_pk_bf16_f32 v161, v74, v75
    v_and_b32 v160, v238, v160
    v_and_b32 v161, v239, v161
    v_mfma_f32_32x32x16_bf16 v[204:219], v[112:115], v[150:153], v[204:219]
    v_exp_f32 v76, v76
    v_exp_f32 v77, v77
    v_exp_f32 v78, v78
    v_exp_f32 v79, v79
    v_cvt_pk_bf16_f32 v162, v76, v77
    v_cvt_pk_bf16_f32 v163, v78, v79
    v_and_b32 v162, v240, v162
    v_and_b32 v163, v241, v163
    v_mfma_f32_32x32x16_bf16 v[204:219], v[116:119], v[154:157], v[204:219]
    v_exp_f32 v80, v80
    v_exp_f32 v81, v81
    v_exp_f32 v82, v82
    v_exp_f32 v83, v83
    v_cvt_pk_bf16_f32 v164, v80, v81
    v_cvt_pk_bf16_f32 v165, v82, v83
    v_and_b32 v164, v242, v164
    v_and_b32 v165, v243, v165
    v_mfma_f32_32x32x16_bf16 v[68:83], v[106:109], a[24:27], 0
    v_exp_f32 v52, v52
    v_exp_f32 v53, v53
    v_exp_f32 v54, v54
    v_exp_f32 v55, v55
    v_cvt_pk_bf16_f32 v150, v52, v53
    v_cvt_pk_bf16_f32 v151, v54, v55
    v_mfma_f32_32x32x16_bf16 v[68:83], v[110:113], a[28:31], v[68:83]
    v_exp_f32 v56, v56
    v_exp_f32 v57, v57
    v_exp_f32 v58, v58
    v_exp_f32 v59, v59
    v_cvt_pk_bf16_f32 v152, v56, v57
    v_cvt_pk_bf16_f32 v153, v58, v59
    v_mfma_f32_32x32x16_bf16 v[204:219], v[126:129], v[158:161], v[204:219]
    v_exp_f32 v60, v60
    v_exp_f32 v61, v61
    v_exp_f32 v62, v62
    v_exp_f32 v63, v63
    v_cvt_pk_bf16_f32 v154, v60, v61
    v_cvt_pk_bf16_f32 v155, v62, v63
    v_mfma_f32_32x32x16_bf16 v[204:219], v[130:133], v[162:165], v[204:219]
    v_exp_f32 v64, v64
    v_exp_f32 v65, v65
    v_exp_f32 v66, v66
    v_exp_f32 v67, v67
    v_cvt_pk_bf16_f32 v156, v64, v65
    v_cvt_pk_bf16_f32 v157, v66, v67
    v_mfma_f32_32x32x16_bf16 v[52:67], v[120:123], a[24:27], 0
    v_exp_f32 v68, v68
    v_exp_f32 v69, v69
    v_exp_f32 v70, v70
    v_exp_f32 v71, v71
    v_cvt_pk_bf16_f32 v158, v68, v69
    v_cvt_pk_bf16_f32 v159, v70, v71
    v_mfma_f32_32x32x16_bf16 v[52:67], v[124:127], a[28:31], v[52:67]
    v_exp_f32 v72, v72
    v_exp_f32 v73, v73
    v_exp_f32 v74, v74
    v_exp_f32 v75, v75
    v_cvt_pk_bf16_f32 v160, v72, v73
    v_cvt_pk_bf16_f32 v161, v74, v75
    v_mfma_f32_32x32x16_bf16 v[220:235], v[98:101], v[150:153], 0
    v_exp_f32 v76, v76
    v_exp_f32 v77, v77
    v_exp_f32 v78, v78
    v_exp_f32 v79, v79
    v_cvt_pk_bf16_f32 v162, v76, v77
    v_cvt_pk_bf16_f32 v163, v78, v79
    v_mfma_f32_32x32x16_bf16 v[220:235], v[102:105], v[154:157], v[220:235]
    v_exp_f32 v80, v80
    v_exp_f32 v81, v81
    v_exp_f32 v82, v82
    v_exp_f32 v83, v83
    v_cvt_pk_bf16_f32 v164, v80, v81
    v_cvt_pk_bf16_f32 v165, v82, v83
    v_mfma_f32_32x32x16_bf16 v[68:83], v[134:137], a[24:27], 0
    v_exp_f32 v52, v52
    v_exp_f32 v53, v53
    v_exp_f32 v54, v54
    v_exp_f32 v55, v55
    v_cvt_pk_bf16_f32 v150, v52, v53
    v_cvt_pk_bf16_f32 v151, v54, v55
    v_mfma_f32_32x32x16_bf16 v[68:83], v[138:141], a[28:31], v[68:83]
    v_exp_f32 v56, v56
    v_exp_f32 v57, v57
    v_exp_f32 v58, v58
    v_exp_f32 v59, v59
    v_cvt_pk_bf16_f32 v152, v56, v57
    v_cvt_pk_bf16_f32 v153, v58, v59
    v_mfma_f32_32x32x16_bf16 v[220:235], v[112:115], v[158:161], v[220:235]
    v_exp_f32 v60, v60
    v_exp_f32 v61, v61
    v_exp_f32 v62, v62
    v_exp_f32 v63, v63
    v_cvt_pk_bf16_f32 v154, v60, v61
    v_cvt_pk_bf16_f32 v155, v62, v63
    v_mfma_f32_32x32x16_bf16 v[220:235], v[116:119], v[162:165], v[220:235]
    v_exp_f32 v64, v64
    v_exp_f32 v65, v65
    v_exp_f32 v66, v66
    v_exp_f32 v67, v67
    s_mov_b64 exec, 3
    buffer_load_dwordx2 v[6:7], v5, s[24:27], 0 offen sc1
    s_mov_b64 exec, -1
    s_waitcnt vmcnt(14)
    v_cvt_pk_bf16_f32 v156, v64, v65
    v_cvt_pk_bf16_f32 v157, v66, v67
    v_mfma_f32_32x32x16_bf16 v[52:67], a[200:203], a[0:3], 0
    v_exp_f32 v68, v68
    v_exp_f32 v69, v69
    v_exp_f32 v70, v70
    v_exp_f32 v71, v71
    v_cvt_pk_bf16_f32 v158, v68, v69
    v_cvt_pk_bf16_f32 v159, v70, v71
    v_and_b32 v158, v236, v158
    v_and_b32 v159, v237, v159
    v_mfma_f32_32x32x16_bf16 v[52:67], a[204:207], a[4:7], v[52:67]
    v_exp_f32 v72, v72
    v_exp_f32 v73, v73
    v_exp_f32 v74, v74
    v_exp_f32 v75, v75
    v_cvt_pk_bf16_f32 v160, v72, v73
    v_cvt_pk_bf16_f32 v161, v74, v75
    v_and_b32 v160, v238, v160
    v_and_b32 v161, v239, v161
    v_mfma_f32_32x32x16_bf16 v[220:235], v[126:129], v[150:153], v[220:235]
    v_exp_f32 v76, v76
    v_exp_f32 v77, v77
    v_exp_f32 v78, v78
    v_exp_f32 v79, v79
    v_cvt_pk_bf16_f32 v162, v76, v77
    v_cvt_pk_bf16_f32 v163, v78, v79
    v_and_b32 v162, v240, v162
    v_and_b32 v163, v241, v163
    v_mfma_f32_32x32x16_bf16 v[220:235], v[130:133], v[154:157], v[220:235]
    v_exp_f32 v80, v80
    v_exp_f32 v81, v81
    v_exp_f32 v82, v82
    v_exp_f32 v83, v83
    v_cvt_pk_bf16_f32 v164, v80, v81
    v_cvt_pk_bf16_f32 v165, v82, v83
    v_and_b32 v164, v242, v164
    v_and_b32 v165, v243, v165
    v_mfma_f32_32x32x16_bf16 v[68:83], a[200:203], a[8:11], 0
    v_exp_f32 v52, v52
    v_exp_f32 v53, v53
    v_exp_f32 v54, v54
    v_exp_f32 v55, v55
    s_add_u32 s64, s35, 0
    s_mul_i32 s65, s64, 41472
    s_mul_i32 s67, s64, 9216
    s_add_u32 m0, s67, 0
    s_nop 0
    buffer_load_dwordx4 v22, s[16:19], s65 offen offset:0 lds
    v_cvt_pk_bf16_f32 v150, v52, v53
    v_cvt_pk_bf16_f32 v151, v54, v55
    v_mfma_f32_32x32x16_bf16 v[68:83], a[204:207], a[12:15], v[68:83]
    v_exp_f32 v56, v56
    v_exp_f32 v57, v57
    v_exp_f32 v58, v58
    v_exp_f32 v59, v59
    buffer_load_dwordx4 v23, s[16:19], s65 offen offset:1024 lds
    v_cvt_pk_bf16_f32 v152, v56, v57
    v_cvt_pk_bf16_f32 v153, v58, v59
    v_mfma_f32_32x32x16_bf16 v[220:235], v[140:143], v[158:161], v[220:235]
    v_exp_f32 v60, v60
    v_exp_f32 v61, v61
    v_exp_f32 v62, v62
    v_exp_f32 v63, v63
    v_cvt_pk_bf16_f32 v154, v60, v61
    v_cvt_pk_bf16_f32 v155, v62, v63
    v_mfma_f32_32x32x16_bf16 v[220:235], v[144:147], v[162:165], v[220:235]
    v_exp_f32 v64, v64
    v_exp_f32 v65, v65
    v_exp_f32 v66, v66
    v_exp_f32 v67, v67
    buffer_load_dwordx4 v24, s[16:19], s65 offen offset:2048 lds
    v_cvt_pk_bf16_f32 v156, v64, v65
    v_cvt_pk_bf16_f32 v157, v66, v67
    v_mfma_f32_32x32x16_bf16 v[52:67], a[200:203], a[16:19], 0
    v_exp_f32 v68, v68
    v_exp_f32 v69, v69
    v_exp_f32 v70, v70
    v_exp_f32 v71, v71
    buffer_load_dwordx4 v25, s[16:19], s65 offen offset:3072 lds
    v_cvt_pk_bf16_f32 v158, v68, v69
    v_cvt_pk_bf16_f32 v159, v70, v71
    v_mfma_f32_32x32x16_bf16 v[52:67], a[204:207], a[20:23], v[52:67]
    v_exp_f32 v72, v72
    v_exp_f32 v73, v73
    v_exp_f32 v74, v74
    v_exp_f32 v75, v75
    s_add_u32 m0, s67, 4096
    s_nop 0
    buffer_load_dwordx4 v26, s[16:19], s65 offen offset:0 lds
    v_cvt_pk_bf16_f32 v160, v72, v73
    v_cvt_pk_bf16_f32 v161, v74, v75
    v_mfma_f32_32x32x16_bf16 v[172:187], a[206:209], v[150:153], v[172:187]
    v_exp_f32 v76, v76
    v_exp_f32 v77, v77
    v_exp_f32 v78, v78
    v_exp_f32 v79, v79
    v_cvt_pk_bf16_f32 v162, v76, v77
    v_cvt_pk_bf16_f32 v163, v78, v79
    v_mfma_f32_32x32x16_bf16 v[172:187], a[210:213], v[154:157], v[172:187]
    v_exp_f32 v80, v80
    v_exp_f32 v81, v81
    v_exp_f32 v82, v82
    v_exp_f32 v83, v83
    buffer_load_dwordx4 v27, s[16:19], s65 offen offset:1024 lds
    v_cvt_pk_bf16_f32 v164, v80, v81
    v_cvt_pk_bf16_f32 v165, v82, v83
    v_mfma_f32_32x32x16_bf16 v[68:83], a[200:203], a[24:27], 0
    v_exp_f32 v52, v52
    v_exp_f32 v53, v53
    v_exp_f32 v54, v54
    v_exp_f32 v55, v55
    buffer_load_dwordx4 v28, s[16:19], s65 offen offset:2048 lds
    v_cvt_pk_bf16_f32 v150, v52, v53
    v_cvt_pk_bf16_f32 v151, v54, v55
    v_mfma_f32_32x32x16_bf16 v[68:83], a[204:207], a[28:31], v[68:83]
    v_exp_f32 v56, v56
    v_exp_f32 v57, v57
    v_exp_f32 v58, v58
    v_exp_f32 v59, v59
    buffer_load_dwordx4 v29, s[16:19], s65 offen offset:3072 lds
    v_cvt_pk_bf16_f32 v152, v56, v57
    v_cvt_pk_bf16_f32 v153, v58, v59
    v_mfma_f32_32x32x16_bf16 v[188:203], a[206:209], v[158:161], v[188:203]
    v_exp_f32 v60, v60
    v_exp_f32 v61, v61
    v_exp_f32 v62, v62
    v_exp_f32 v63, v63
    v_cvt_pk_bf16_f32 v154, v60, v61
    v_cvt_pk_bf16_f32 v155, v62, v63
    v_mfma_f32_32x32x16_bf16 v[188:203], a[210:213], v[162:165], v[188:203]
    v_exp_f32 v64, v64
    v_exp_f32 v65, v65
    v_exp_f32 v66, v66
    v_exp_f32 v67, v67
    s_add_u32 m0, s67, 8192
    s_nop 0
    buffer_load_dwordx4 v14, s[16:19], s65 offen lds
    s_waitcnt vmcnt(19)
    v_cvt_pk_bf16_f32 v156, v64, v65
    v_cvt_pk_bf16_f32 v157, v66, v67
    v_mfma_f32_32x32x16_bf16 v[52:67], a[214:217], a[0:3], 0
    v_exp_f32 v68, v68
    v_exp_f32 v69, v69
    v_exp_f32 v70, v70
    v_exp_f32 v71, v71
    s_add_u32 s64, s35, 4
    s_mul_i32 s65, s64, 41472
    s_mul_i32 s67, s64, 9216
    s_add_u32 m0, s67, 0
    s_nop 0
    buffer_load_dwordx4 v22, s[16:19], s65 offen offset:0 lds
    v_cvt_pk_bf16_f32 v158, v68, v69
    v_cvt_pk_bf16_f32 v159, v70, v71
    v_mfma_f32_32x32x16_bf16 v[52:67], a[218:221], a[4:7], v[52:67]
    v_exp_f32 v72, v72
    v_exp_f32 v73, v73
    v_exp_f32 v74, v74
    v_exp_f32 v75, v75
    buffer_load_dwordx4 v23, s[16:19], s65 offen offset:1024 lds
    v_cvt_pk_bf16_f32 v160, v72, v73
    v_cvt_pk_bf16_f32 v161, v74, v75
    v_mfma_f32_32x32x16_bf16 v[204:219], a[206:209], v[150:153], v[204:219]
    v_exp_f32 v76, v76
    v_exp_f32 v77, v77
    v_exp_f32 v78, v78
    v_exp_f32 v79, v79
    v_cvt_pk_bf16_f32 v162, v76, v77
    v_cvt_pk_bf16_f32 v163, v78, v79
    v_mfma_f32_32x32x16_bf16 v[204:219], a[210:213], v[154:157], v[204:219]
    v_exp_f32 v80, v80
    v_exp_f32 v81, v81
    v_exp_f32 v82, v82
    v_exp_f32 v83, v83
    buffer_load_dwordx4 v24, s[16:19], s65 offen offset:2048 lds
    s_waitcnt vmcnt(12)
    s_mov_b32 s76, 200000
L_chk1:
    s_cmp_eq_u32 s33, 0
    s_cbranch_scc1 L_ok1
    s_mov_b64 exec, 3
    v_subrev_u32 v8, s69, v7
    v_cmp_eq_u32 vcc, s68, v6
    v_cmp_le_u32 s[4:5], 4, v8
    v_cmp_ge_u32 s[6:7], 4, v8
    s_mov_b64 exec, -1
    s_and_b64 s[4:5], s[4:5], vcc
    s_and_b64 s[4:5], s[4:5], s[6:7]
    s_and_b32 s4, s4, 3
    s_cmp_eq_u32 s4, 3
    s_cbranch_scc1 L_ok1
    s_mov_b64 exec, 3
    buffer_load_dwordx2 v[6:7], v5, s[24:27], 0 offen sc1
    s_mov_b64 exec, -1
    s_waitcnt vmcnt(0)
    s_sub_u32 s76, s76, 1
    s_cmp_lg_u32 s76, 0
    s_cbranch_scc1 L_chk1
L_ok1:
    v_cvt_pk_bf16_f32 v164, v80, v81
    v_cvt_pk_bf16_f32 v165, v82, v83
    v_mfma_f32_32x32x16_bf16 v[68:83], a[214:217], a[8:11], 0
    v_exp_f32 v52, v52
    v_exp_f32 v53, v53
    v_exp_f32 v54, v54
    v_exp_f32 v55, v55
    s_add_u32 s63, s71, 18432
    buffer_load_dwordx4 a[228:231], v44, s[24:27], s63 offen sc1
    buffer_load_dword a232, v45, s[24:27], s63 offen sc1
    s_mov_b64 exec, s[54:55]
    buffer_load_dwordx4 a[234:237], v46, s[24:27], s63 offen sc1
    buffer_load_dwordx4 a[238:241], v46, s[24:27], s63 offen offset:576 sc1
    s_mov_b64 exec, -1
    v_cvt_pk_bf16_f32 v150, v52, v53
    v_cvt_pk_bf16_f32 v151, v54, v55
    v_mfma_f32_32x32x16_bf16 v[68:83], a[218:221], a[12:15], v[68:83]
    v_exp_f32 v56, v56
    v_exp_f32 v57, v57
    v_exp_f32 v58, v58
    v_exp_f32 v59, v59
    v_cvt_pk_bf16_f32 v152, v56, v57
    v_cvt_pk_bf16_f32 v153, v58, v59
    v_mfma_f32_32x32x16_bf16 v[220:235], a[206:209], v[158:161], v[220:235]
    v_exp_f32 v60, v60
    v_exp_f32 v61, v61
    v_exp_f32 v62, v62
    v_exp_f32 v63, v63
    s_add_u32 s63, s71, 27648
    buffer_load_dwordx4 a[242:245], v44, s[24:27], s63 offen sc1
    buffer_load_dword a246, v45, s[24:27], s63 offen sc1
    s_mov_b64 exec, s[54:55]
    buffer_load_dwordx4 a[248:251], v46, s[24:27], s63 offen sc1
    buffer_load_dwordx4 a[252:255], v46, s[24:27], s63 offen offset:576 sc1
    s_mov_b64 exec, -1
    v_cvt_pk_bf16_f32 v154, v60, v61
    v_cvt_pk_bf16_f32 v155, v62, v63
    v_mfma_f32_32x32x16_bf16 v[220:235], a[210:213], v[162:165], v[220:235]
    v_exp_f32 v64, v64
    v_exp_f32 v65, v65
    v_exp_f32 v66, v66
    v_exp_f32 v67, v67
    v_cvt_pk_bf16_f32 v156, v64, v65
    v_cvt_pk_bf16_f32 v157, v66, v67
    v_mfma_f32_32x32x16_bf16 v[52:67], a[214:217], a[16:19], 0
    v_exp_f32 v68, v68
    v_exp_f32 v69, v69
    v_exp_f32 v70, v70
    v_exp_f32 v71, v71
    s_add_u32 s63, s72, 18432
    buffer_load_dwordx4 a[172:175], v44, s[24:27], s63 offen sc1
    buffer_load_dword a176, v45, s[24:27], s63 offen sc1
    s_mov_b64 exec, s[54:55]
    buffer_load_dwordx4 a[178:181], v46, s[24:27], s63 offen sc1
    buffer_load_dwordx4 a[182:185], v46, s[24:27], s63 offen offset:576 sc1
    s_mov_b64 exec, -1
    v_cvt_pk_bf16_f32 v158, v68, v69
    v_cvt_pk_bf16_f32 v159, v70, v71
    v_mfma_f32_32x32x16_bf16 v[52:67], a[218:221], a[20:23], v[52:67]
    v_exp_f32 v72, v72
    v_exp_f32 v73, v73
    v_exp_f32 v74, v74
    v_exp_f32 v75, v75
    v_cvt_pk_bf16_f32 v160, v72, v73
    v_cvt_pk_bf16_f32 v161, v74, v75
    v_mfma_f32_32x32x16_bf16 v[172:187], a[220:223], v[150:153], v[172:187]
    v_exp_f32 v76, v76
    v_exp_f32 v77, v77
    v_exp_f32 v78, v78
    v_exp_f32 v79, v79
    s_add_u32 s63, s72, 27648
    buffer_load_dwordx4 a[186:189], v44, s[24:27], s63 offen sc1
    buffer_load_dword a190, v45, s[24:27], s63 offen sc1
    s_mov_b64 exec, s[54:55]
    buffer_load_dwordx4 a[192:195], v46, s[24:27], s63 offen sc1
    buffer_load_dwordx4 a[196:199], v46, s[24:27], s63 offen offset:576 sc1
    s_mov_b64 exec, -1
    v_cvt_pk_bf16_f32 v162, v76, v77
    v_cvt_pk_bf16_f32 v163, v78, v79
    v_mfma_f32_32x32x16_bf16 v[172:187], a[224:227], v[154:157], v[172:187]
    v_exp_f32 v80, v80
    v_exp_f32 v81, v81
    v_exp_f32 v82, v82
    v_exp_f32 v83, v83
    v_cvt_pk_bf16_f32 v164, v80, v81
    v_cvt_pk_bf16_f32 v165, v82, v83
    v_mfma_f32_32x32x16_bf16 v[68:83], a[214:217], a[24:27], 0
    v_exp_f32 v52, v52
    v_exp_f32 v53, v53
    v_exp_f32 v54, v54
    v_exp_f32 v55, v55
    v_cvt_pk_bf16_f32 v150, v52, v53
    v_cvt_pk_bf16_f32 v151, v54, v55
    v_mfma_f32_32x32x16_bf16 v[68:83], a[218:221], a[28:31], v[68:83]
    v_exp_f32 v56, v56
    v_exp_f32 v57, v57
    v_exp_f32 v58, v58
    v_exp_f32 v59, v59
    v_cvt_pk_bf16_f32 v152, v56, v57
    v_cvt_pk_bf16_f32 v153, v58, v59
    v_mfma_f32_32x32x16_bf16 v[188:203], a[220:223], v[158:161], v[188:203]
    v_exp_f32 v60, v60
    v_exp_f32 v61, v61
    v_exp_f32 v62, v62
    v_exp_f32 v63, v63
    v_cvt_pk_bf16_f32 v154, v60, v61
    v_cvt_pk_bf16_f32 v155, v62, v63
    v_mfma_f32_32x32x16_bf16 v[188:203], a[224:227], v[162:165], v[188:203]
    v_exp_f32 v64, v64
    v_exp_f32 v65, v65
    v_exp_f32 v66, v66
    v_exp_f32 v67, v67
    s_waitcnt vmcnt(34)
    v_cvt_pk_bf16_f32 v156, v64, v65
    v_cvt_pk_bf16_f32 v157, v66, v67
    v_mfma_f32_32x32x16_bf16 v[52:67], a[144:147], a[0:3], 0
    v_exp_f32 v68, v68
    v_exp_f32 v69, v69
    v_exp_f32 v70, v70
    v_exp_f32 v71, v71
    v_cvt_pk_bf16_f32 v158, v68, v69
    v_cvt_pk_bf16_f32 v159, v70, v71
    v_mfma_f32_32x32x16_bf16 v[52:67], a[148:151], a[4:7], v[52:67]
    v_exp_f32 v72, v72
    v_exp_f32 v73, v73
    v_exp_f32 v74, v74
    v_exp_f32 v75, v75
    v_cvt_pk_bf16_f32 v160, v72, v73
    v_cvt_pk_bf16_f32 v161, v74, v75
    v_mfma_f32_32x32x16_bf16 v[204:219], a[220:223], v[150:153], v[204:219]
    v_exp_f32 v76, v76
    v_exp_f32 v77, v77
    v_exp_f32 v78, v78
    v_exp_f32 v79, v79
    v_cvt_pk_bf16_f32 v162, v76, v77
    v_cvt_pk_bf16_f32 v163, v78, v79
    v_mfma_f32_32x32x16_bf16 v[204:219], a[224:227], v[154:157], v[204:219]
    v_exp_f32 v80, v80
    v_exp_f32 v81, v81
    v_exp_f32 v82, v82
    v_exp_f32 v83, v83
    s_waitcnt vmcnt(30)
    v_cvt_pk_bf16_f32 v164, v80, v81
    v_cvt_pk_bf16_f32 v165, v82, v83
    v_mfma_f32_32x32x16_bf16 v[68:83], a[158:161], a[0:3], 0
    v_exp_f32 v52, v52
    v_exp_f32 v53, v53
    v_exp_f32 v54, v54
    v_exp_f32 v55, v55
    v_cvt_pk_bf16_f32 v150, v52, v53
    v_cvt_pk_bf16_f32 v151, v54, v55
    v_and_b32 v150, v244, v150
    v_and_b32 v151, v245, v151
    v_mfma_f32_32x32x16_bf16 v[68:83], a[162:165], a[4:7], v[68:83]
    v_exp_f32 v56, v56
    v_exp_f32 v57, v57
    v_exp_f32 v58, v58
    v_exp_f32 v59, v59
    v_cvt_pk_bf16_f32 v152, v56, v57
    v_cvt_pk_bf16_f32 v153, v58, v59
    v_and_b32 v152, v246, v152
    v_and_b32 v153, v247, v153
    v_mfma_f32_32x32x16_bf16 v[220:235], a[220:223], v[158:161], v[220:235]
    v_exp_f32 v60, v60
    v_exp_f32 v61, v61
    v_exp_f32 v62, v62
    v_exp_f32 v63, v63
    v_cvt_pk_bf16_f32 v154, v60, v61
    v_cvt_pk_bf16_f32 v155, v62, v63
    v_and_b32 v154, v248, v154
    v_and_b32 v155, v249, v155
    v_mfma_f32_32x32x16_bf16 v[220:235], a[224:227], v[162:165], v[220:235]
    v_exp_f32 v64, v64
    v_exp_f32 v65, v65
    v_exp_f32 v66, v66
    v_exp_f32 v67, v67
    v_cvt_pk_bf16_f32 v156, v64, v65
    v_cvt_pk_bf16_f32 v157, v66, v67
    v_and_b32 v156, v250, v156
    v_and_b32 v157, v251, v157
    v_mfma_f32_32x32x16_bf16 v[52:67], a[158:161], a[8:11], 0
    v_exp_f32 v68, v68
    v_exp_f32 v69, v69
    v_exp_f32 v70, v70
    v_exp_f32 v71, v71
    v_cvt_pk_bf16_f32 v158, v68, v69
    v_cvt_pk_bf16_f32 v159, v70, v71
    v_mfma_f32_32x32x16_bf16 v[52:67], a[162:165], a[12:15], v[52:67]
    v_exp_f32 v72, v72
    v_exp_f32 v73, v73
    v_exp_f32 v74, v74
    v_exp_f32 v75, v75
    v_cvt_pk_bf16_f32 v160, v72, v73
    v_cvt_pk_bf16_f32 v161, v74, v75
    v_mfma_f32_32x32x16_bf16 v[172:187], a[150:153], v[150:153], v[172:187]
    v_exp_f32 v76, v76
    v_exp_f32 v77, v77
    v_exp_f32 v78, v78
    v_exp_f32 v79, v79
    v_cvt_pk_bf16_f32 v162, v76, v77
    v_cvt_pk_bf16_f32 v163, v78, v79
    v_mfma_f32_32x32x16_bf16 v[172:187], a[154:157], v[154:157], v[172:187]
    v_exp_f32 v80, v80
    v_exp_f32 v81, v81
    v_exp_f32 v82, v82
    v_exp_f32 v83, v83
    s_waitcnt vmcnt(12)
    v_cvt_pk_bf16_f32 v164, v80, v81
    v_cvt_pk_bf16_f32 v165, v82, v83
    v_mfma_f32_32x32x16_bf16 v[68:83], a[228:231], a[0:3], 0
    v_exp_f32 v52, v52
    v_exp_f32 v53, v53
    v_exp_f32 v54, v54
    v_exp_f32 v55, v55
    v_cvt_pk_bf16_f32 v150, v52, v53
    v_cvt_pk_bf16_f32 v151, v54, v55
    v_and_b32 v150, v244, v150
    v_and_b32 v151, v245, v151
    v_mfma_f32_32x32x16_bf16 v[68:83], a[232:235], a[4:7], v[68:83]
    v_exp_f32 v56, v56
    v_exp_f32 v57, v57
    v_exp_f32 v58, v58
    v_exp_f32 v59, v59
    v_cvt_pk_bf16_f32 v152, v56, v57
    v_cvt_pk_bf16_f32 v153, v58, v59
    v_and_b32 v152, v246, v152
    v_and_b32 v153, v247, v153
    v_mfma_f32_32x32x16_bf16 v[172:187], a[164:167], v[158:161], v[172:187]
    v_exp_f32 v60, v60
    v_exp_f32 v61, v61
    v_exp_f32 v62, v62
    v_exp_f32 v63, v63
    v_cvt_pk_bf16_f32 v154, v60, v61
    v_cvt_pk_bf16_f32 v155, v62, v63
    v_and_b32 v154, v248, v154
    v_and_b32 v155, v249, v155
    v_mfma_f32_32x32x16_bf16 v[172:187], a[168:171], v[162:165], v[172:187]
    v_exp_f32 v64, v64
    v_exp_f32 v65, v65
    v_exp_f32 v66, v66
    v_exp_f32 v67, v67
    v_cvt_pk_bf16_f32 v156, v64, v65
    v_cvt_pk_bf16_f32 v157, v66, v67
    v_and_b32 v156, v250, v156
    v_and_b32 v157, v251, v157
    v_mfma_f32_32x32x16_bf16 v[52:67], a[228:231], a[8:11], 0
    v_exp_f32 v68, v68
    v_exp_f32 v69, v69
    v_exp_f32 v70, v70
    v_exp_f32 v71, v71
    v_cvt_pk_bf16_f32 v158, v68, v69
    v_cvt_pk_bf16_f32 v159, v70, v71
    v_mfma_f32_32x32x16_bf16 v[52:67], a[232:235], a[12:15], v[52:67]
    v_exp_f32 v72, v72
    v_exp_f32 v73, v73
    v_exp_f32 v74, v74
    v_exp_f32 v75, v75
    v_cvt_pk_bf16_f32 v160, v72, v73
    v_cvt_pk_bf16_f32 v161, v74, v75
    v_mfma_f32_32x32x16_bf16 v[188:203], a[164:167], v[150:153], v[188:203]
    v_exp_f32 v76, v76
    v_exp_f32 v77, v77
    v_exp_f32 v78, v78
    v_exp_f32 v79, v79
    v_cvt_pk_bf16_f32 v162, v76, v77
    v_cvt_pk_bf16_f32 v163, v78, v79
    v_mfma_f32_32x32x16_bf16 v[188:203], a[168:171], v[154:157], v[188:203]
    v_exp_f32 v80, v80
    v_exp_f32 v81, v81
    v_exp_f32 v82, v82
    v_exp_f32 v83, v83
    v_cvt_pk_bf16_f32 v164, v80, v81
    v_cvt_pk_bf16_f32 v165, v82, v83
    v_mfma_f32_32x32x16_bf16 v[68:83], a[228:231], a[16:19], 0
    v_exp_f32 v52, v52
    v_exp_f32 v53, v53
    v_exp_f32 v54, v54
    v_exp_f32 v55, v55
    v_cvt_pk_bf16_f32 v150, v52, v53
    v_cvt_pk_bf16_f32 v151, v54, v55
    v_mfma_f32_32x32x16_bf16 v[68:83], a[232:235], a[20:23], v[68:83]
    v_exp_f32 v56, v56
    v_exp_f32 v57, v57
    v_exp_f32 v58, v58
    v_exp_f32 v59, v59
    v_cvt_pk_bf16_f32 v152, v56, v57
    v_cvt_pk_bf16_f32 v153, v58, v59
    v_mfma_f32_32x32x16_bf16 v[172:187], a[234:237], v[158:161], v[172:187]
    v_exp_f32 v60, v60
    v_exp_f32 v61, v61
    v_exp_f32 v62, v62
    v_exp_f32 v63, v63
    v_cvt_pk_bf16_f32 v154, v60, v61
    v_cvt_pk_bf16_f32 v155, v62, v63
    v_mfma_f32_32x32x16_bf16 v[172:187], a[238:241], v[162:165], v[172:187]
    v_exp_f32 v64, v64
    v_exp_f32 v65, v65
    v_exp_f32 v66, v66
    v_exp_f32 v67, v67
    v_cvt_pk_bf16_f32 v156, v64, v65
    v_cvt_pk_bf16_f32 v157, v66, v67
    v_mfma_f32_32x32x16_bf16 v[52:67], a[228:231], a[24:27], 0
    v_exp_f32 v68, v68
    v_exp_f32 v69, v69
    v_exp_f32 v70, v70
    v_exp_f32 v71, v71
    buffer_load_dwordx4 v25, s[16:19], s65 offen offset:3072 lds
    v_cvt_pk_bf16_f32 v158, v68, v69
    v_cvt_pk_bf16_f32 v159, v70, v71
    v_mfma_f32_32x32x16_bf16 v[52:67], a[232:235], a[28:31], v[52:67]
    v_exp_f32 v72, v72
    v_exp_f32 v73, v73
    v_exp_f32 v74, v74
    v_exp_f32 v75, v75
    s_add_u32 m0, s67, 4096
    s_nop 0
    buffer_load_dwordx4 v26, s[16:19], s65 offen offset:0 lds
    v_cvt_pk_bf16_f32 v160, v72, v73
    v_cvt_pk_bf16_f32 v161, v74, v75
    v_mfma_f32_32x32x16_bf16 v[188:203], a[234:237], v[150:153], v[188:203]
    v_exp_f32 v76, v76
    v_exp_f32 v77, v77
    v_exp_f32 v78, v78
    v_exp_f32 v79, v79
    v_cvt_pk_bf16_f32 v162, v76, v77
    v_cvt_pk_bf16_f32 v163, v78, v79
    v_mfma_f32_32x32x16_bf16 v[188:203], a[238:241], v[154:157], v[188:203]
    v_exp_f32 v80, v80
    v_exp_f32 v81, v81
    v_exp_f32 v82, v82
    v_exp_f32 v83, v83
    buffer_load_dwordx4 v27, s[16:19], s65 offen offset:1024 lds
    s_waitcnt vmcnt(11)
    v_cvt_pk_bf16_f32 v164, v80, v81
    v_cvt_pk_bf16_f32 v165, v82, v83
    v_mfma_f32_32x32x16_bf16 v[68:83], a[242:245], a[0:3], 0
    v_exp_f32 v52, v52
    v_exp_f32 v53, v53
    v_exp_f32 v54, v54
    v_exp_f32 v55, v55
    buffer_load_dwordx4 v28, s[16:19], s65 offen offset:2048 lds
    v_cvt_pk_bf16_f32 v150, v52, v53
    v_cvt_pk_bf16_f32 v151, v54, v55
    v_mfma_f32_32x32x16_bf16 v[68:83], a[246:249], a[4:7], v[68:83]
    v_exp_f32 v56, v56
    v_exp_f32 v57, v57
    v_exp_f32 v58, v58
    v_exp_f32 v59, v59
    buffer_load_dwordx4 v29, s[16:19], s65 offen offset:3072 lds
    v_cvt_pk_bf16_f32 v152, v56, v57
    v_cvt_pk_bf16_f32 v153, v58, v59
    v_mfma_f32_32x32x16_bf16 v[204:219], a[234:237], v[158:161], v[204:219]
    v_exp_f32 v60, v60
    v_exp_f32 v61, v61
    v_exp_f32 v62, v62
    v_exp_f32 v63, v63
    v_cvt_pk_bf16_f32 v154, v60, v61
    v_cvt_pk_bf16_f32 v155, v62, v63
    v_mfma_f32_32x32x16_bf16 v[204:219], a[238:241], v[162:165], v[204:219]
    v_exp_f32 v64, v64
    v_exp_f32 v65, v65
    v_exp_f32 v66, v66
    v_exp_f32 v67, v67
    s_add_u32 m0, s67, 8192
    s_nop 0
    buffer_load_dwordx4 v14, s[16:19], s65 offen lds
    v_cvt_pk_bf16_f32 v156, v64, v65
    v_cvt_pk_bf16_f32 v157, v66, v67
    v_mfma_f32_32x32x16_bf16 v[52:67], a[242:245], a[8:11], 0
    v_exp_f32 v68, v68
    v_exp_f32 v69, v69
    v_exp_f32 v70, v70
    v_exp_f32 v71, v71
    s_add_u32 s64, s35, 8
    s_mul_i32 s65, s64, 41472
    s_mul_i32 s67, s64, 9216
    s_add_u32 m0, s67, 0
    s_nop 0
    buffer_load_dwordx4 v22, s[16:19], s65 offen offset:0 lds
    v_cvt_pk_bf16_f32 v158, v68, v69
    v_cvt_pk_bf16_f32 v159, v70, v71
    v_mfma_f32_32x32x16_bf16 v[52:67], a[246:249], a[12:15], v[52:67]
    v_exp_f32 v72, v72
    v_exp_f32 v73, v73
    v_exp_f32 v74, v74
    v_exp_f32 v75, v75
    buffer_load_dwordx4 v23, s[16:19], s65 offen offset:1024 lds
    v_cvt_pk_bf16_f32 v160, v72, v73
    v_cvt_pk_bf16_f32 v161, v74, v75
    v_mfma_f32_32x32x16_bf16 v[220:235], a[234:237], v[150:153], v[220:235]
    v_exp_f32 v76, v76
    v_exp_f32 v77, v77
    v_exp_f32 v78, v78
    v_exp_f32 v79, v79
    v_cvt_pk_bf16_f32 v162, v76, v77
    v_cvt_pk_bf16_f32 v163, v78, v79
    v_mfma_f32_32x32x16_bf16 v[220:235], a[238:241], v[154:157], v[220:235]
    v_exp_f32 v80, v80
    v_exp_f32 v81, v81
    v_exp_f32 v82, v82
    v_exp_f32 v83, v83
    buffer_load_dwordx4 v24, s[16:19], s65 offen offset:2048 lds
    v_cvt_pk_bf16_f32 v164, v80, v81
    v_cvt_pk_bf16_f32 v165, v82, v83
    v_mfma_f32_32x32x16_bf16 v[68:83], a[242:245], a[16:19], 0
    v_exp_f32 v52, v52
    v_exp_f32 v53, v53
    v_exp_f32 v54, v54
    v_exp_f32 v55, v55
    buffer_load_dwordx4 v25, s[16:19], s65 offen offset:3072 lds
    v_cvt_pk_bf16_f32 v150, v52, v53
    v_cvt_pk_bf16_f32 v151, v54, v55
    v_mfma_f32_32x32x16_bf16 v[68:83], a[246:249], a[20:23], v[68:83]
    v_exp_f32 v56, v56
    v_exp_f32 v57, v57
    v_exp_f32 v58, v58
    v_exp_f32 v59, v59
    s_add_u32 m0, s67, 4096
    s_nop 0
    buffer_load_dwordx4 v26, s[16:19], s65 offen offset:0 lds
    v_cvt_pk_bf16_f32 v152, v56, v57
    v_cvt_pk_bf16_f32 v153, v58, v59
    v_mfma_f32_32x32x16_bf16 v[172:187], a[248:251], v[158:161], v[172:187]
    v_exp_f32 v60, v60
    v_exp_f32 v61, v61
    v_exp_f32 v62, v62
    v_exp_f32 v63, v63
    v_cvt_pk_bf16_f32 v154, v60, v61
    v_cvt_pk_bf16_f32 v155, v62, v63
    v_mfma_f32_32x32x16_bf16 v[172:187], a[252:255], v[162:165], v[172:187]
    v_exp_f32 v64, v64
    v_exp_f32 v65, v65
    v_exp_f32 v66, v66
    v_exp_f32 v67, v67
    buffer_load_dwordx4 v27, s[16:19], s65 offen offset:1024 lds
    v_cvt_pk_bf16_f32 v156, v64, v65
    v_cvt_pk_bf16_f32 v157, v66, v67
    v_mfma_f32_32x32x16_bf16 v[52:67], a[242:245], a[24:27], 0
    v_exp_f32 v68, v68
    v_exp_f32 v69, v69
    v_exp_f32 v70, v70
    v_exp_f32 v71, v71
    buffer_load_dwordx4 v28, s[16:19], s65 offen offset:2048 lds
    v_cvt_pk_bf16_f32 v158, v68, v69
    v_cvt_pk_bf16_f32 v159, v70, v71
    v_mfma_f32_32x32x16_bf16 v[52:67], a[246:249], a[28:31], v[52:67]
    v_exp_f32 v72, v72
    v_exp_f32 v73, v73
    v_exp_f32 v74, v74
    v_exp_f32 v75, v75
    buffer_load_dwordx4 v29, s[16:19], s65 offen offset:3072 lds
    v_cvt_pk_bf16_f32 v160, v72, v73
    v_cvt_pk_bf16_f32 v161, v74, v75
    v_mfma_f32_32x32x16_bf16 v[188:203], a[248:251], v[150:153], v[188:203]
    v_exp_f32 v76, v76
    v_exp_f32 v77, v77
    v_exp_f32 v78, v78
    v_exp_f32 v79, v79
    v_cvt_pk_bf16_f32 v162, v76, v77
    v_cvt_pk_bf16_f32 v163, v78, v79
    v_mfma_f32_32x32x16_bf16 v[188:203], a[252:255], v[154:157], v[188:203]
    v_exp_f32 v80, v80
    v_exp_f32 v81, v81
    v_exp_f32 v82, v82
    v_exp_f32 v83, v83
    s_add_u32 m0, s67, 8192
    s_nop 0
    buffer_load_dwordx4 v14, s[16:19], s65 offen lds
    s_waitcnt vmcnt(19)
    v_cvt_pk_bf16_f32 v164, v80, v81
    v_cvt_pk_bf16_f32 v165, v82, v83
    v_mfma_f32_32x32x16_bf16 v[68:83], a[172:175], a[0:3], 0
    v_exp_f32 v52, v52
    v_exp_f32 v53, v53
    v_exp_f32 v54, v54
    v_exp_f32 v55, v55
    s_add_u32 s64, s35, 12
    s_mul_i32 s65, s64, 41472
    s_mul_i32 s67, s64, 9216
    s_add_u32 m0, s67, 0
    s_nop 0
    buffer_load_dwordx4 v22, s[16:19], s65 offen offset:0 lds
    v_cvt_pk_bf16_f32 v150, v52, v53
    v_cvt_pk_bf16_f32 v151, v54, v55
    v_mfma_f32_32x32x16_bf16 v[68:83], a[176:179], a[4:7], v[68:83]
    v_exp_f32 v56, v56
    v_exp_f32 v57, v57
    v_exp_f32 v58, v58
    v_exp_f32 v59, v59
    buffer_load_dwordx4 v23, s[16:19], s65 offen offset:1024 lds
    v_cvt_pk_bf16_f32 v152, v56, v57
    v_cvt_pk_bf16_f32 v153, v58, v59
    v_mfma_f32_32x32x16_bf16 v[204:219], a[248:251], v[158:161], v[204:219]
    v_exp_f32 v60, v60
    v_exp_f32 v61, v61
    v_exp_f32 v62, v62
    v_exp_f32 v63, v63
    v_cvt_pk_bf16_f32 v154, v60, v61
    v_cvt_pk_bf16_f32 v155, v62, v63
    v_mfma_f32_32x32x16_bf16 v[204:219], a[252:255], v[162:165], v[204:219]
    v_exp_f32 v64, v64
    v_exp_f32 v65, v65
    v_exp_f32 v66, v66
    v_exp_f32 v67, v67
    buffer_load_dwordx4 v24, s[16:19], s65 offen offset:2048 lds
    v_cvt_pk_bf16_f32 v156, v64, v65
    v_cvt_pk_bf16_f32 v157, v66, v67
    v_mfma_f32_32x32x16_bf16 v[52:67], a[172:175], a[8:11], 0
    v_exp_f32 v68, v68
    v_exp_f32 v69, v69
    v_exp_f32 v70, v70
    v_exp_f32 v71, v71
    buffer_load_dwordx4 v25, s[16:19], s65 offen offset:3072 lds
    v_cvt_pk_bf16_f32 v158, v68, v69
    v_cvt_pk_bf16_f32 v159, v70, v71
    v_mfma_f32_32x32x16_bf16 v[52:67], a[176:179], a[12:15], v[52:67]
    v_exp_f32 v72, v72
    v_exp_f32 v73, v73
    v_exp_f32 v74, v74
    v_exp_f32 v75, v75
    s_add_u32 m0, s67, 4096
    s_nop 0
    buffer_load_dwordx4 v26, s[16:19], s65 offen offset:0 lds
    v_cvt_pk_bf16_f32 v160, v72, v73
    v_cvt_pk_bf16_f32 v161, v74, v75
    v_mfma_f32_32x32x16_bf16 v[220:235], a[248:251], v[150:153], v[220:235]
    v_exp_f32 v76, v76
    v_exp_f32 v77, v77
    v_exp_f32 v78, v78
    v_exp_f32 v79, v79
    v_cvt_pk_bf16_f32 v162, v76, v77
    v_cvt_pk_bf16_f32 v163, v78, v79
    v_mfma_f32_32x32x16_bf16 v[220:235], a[252:255], v[154:157], v[220:235]
    v_exp_f32 v80, v80
    v_exp_f32 v81, v81
    v_exp_f32 v82, v82
    v_exp_f32 v83, v83
    buffer_load_dwordx4 v27, s[16:19], s65 offen offset:1024 lds
    v_cvt_pk_bf16_f32 v164, v80, v81
    v_cvt_pk_bf16_f32 v165, v82, v83
    v_mfma_f32_32x32x16_bf16 v[68:83], a[172:175], a[16:19], 0
    v_exp_f32 v52, v52
    v_exp_f32 v53, v53
    v_exp_f32 v54, v54
    v_exp_f32 v55, v55
    buffer_load_dwordx4 v28, s[16:19], s65 offen offset:2048 lds
    v_cvt_pk_bf16_f32 v150, v52, v53
    v_cvt_pk_bf16_f32 v151, v54, v55
    v_mfma_f32_32x32x16_bf16 v[68:83], a[176:179], a[20:23], v[68:83]
    v_exp_f32 v56, v56
    v_exp_f32 v57, v57
    v_exp_f32 v58, v58
    v_exp_f32 v59, v59
    buffer_load_dwordx4 v29, s[16:19], s65 offen offset:3072 lds
    v_cvt_pk_bf16_f32 v152, v56, v57
    v_cvt_pk_bf16_f32 v153, v58, v59
    v_mfma_f32_32x32x16_bf16 v[172:187], a[178:181], v[158:161], v[172:187]
    v_exp_f32 v60, v60
    v_exp_f32 v61, v61
    v_exp_f32 v62, v62
    v_exp_f32 v63, v63
    v_cvt_pk_bf16_f32 v154, v60, v61
    v_cvt_pk_bf16_f32 v155, v62, v63
    v_mfma_f32_32x32x16_bf16 v[172:187], a[182:185], v[162:165], v[172:187]
    v_exp_f32 v64, v64
    v_exp_f32 v65, v65
    v_exp_f32 v66, v66
    v_exp_f32 v67, v67
    s_add_u32 m0, s67, 8192
    s_nop 0
    buffer_load_dwordx4 v14, s[16:19], s65 offen lds
    s_waitcnt vmcnt(24)
    v_cvt_pk_bf16_f32 v156, v64, v65
    v_cvt_pk_bf16_f32 v157, v66, v67
    v_mfma_f32_32x32x16_bf16 v[52:67], a[186:189], a[0:3], 0
    v_exp_f32 v68, v68
    v_exp_f32 v69, v69
    v_exp_f32 v70, v70
    v_exp_f32 v71, v71
    s_lshl_b32 s64, s35, 1
    s_and_b32 s64, s64, 3
    s_lshl_b32 s64, s64, 2
    s_lshr_b32 s65, s35, 1
    s_lshl_b32 s65, s65, 1
    s_add_u32 s64, s64, s65
    s_mul_i32 s64, s64, 20736
    s_add_u32 s65, s64, 18432
    s_lshl_b32 s64, s35, 11
    s_add_u32 m0, s64, 147456
    s_nop 0
    buffer_load_dwordx4 v12, s[16:19], s65 offen lds
    v_cvt_pk_bf16_f32 v158, v68, v69
    v_cvt_pk_bf16_f32 v159, v70, v71
    v_and_b32 v158, v244, v158
    v_and_b32 v159, v245, v159
    v_mfma_f32_32x32x16_bf16 v[52:67], a[190:193], a[4:7], v[52:67]
    v_exp_f32 v72, v72
    v_exp_f32 v73, v73
    v_exp_f32 v74, v74
    v_exp_f32 v75, v75
    s_add_u32 s65, s65, 81920
    buffer_load_dwordx4 v13, s[16:19], s65 offen offset:1024 lds
    v_cvt_pk_bf16_f32 v160, v72, v73
    v_cvt_pk_bf16_f32 v161, v74, v75
    v_and_b32 v160, v246, v160
    v_and_b32 v161, v247, v161
    v_mfma_f32_32x32x16_bf16 v[188:203], a[178:181], v[150:153], v[188:203]
    v_exp_f32 v76, v76
    v_exp_f32 v77, v77
    v_exp_f32 v78, v78
    v_exp_f32 v79, v79
    v_cvt_pk_bf16_f32 v162, v76, v77
    v_cvt_pk_bf16_f32 v163, v78, v79
    v_and_b32 v162, v248, v162
    v_and_b32 v163, v249, v163
    v_mfma_f32_32x32x16_bf16 v[188:203], a[182:185], v[154:157], v[188:203]
    v_exp_f32 v80, v80
    v_exp_f32 v81, v81
    v_exp_f32 v82, v82
    v_exp_f32 v83, v83
    s_mov_b32 s65, 0
    s_mov_b32 m0, 155648
    s_nop 0
    buffer_load_dwordx4 v15, s[16:19], s65 offen lds
    v_cvt_pk_bf16_f32 v164, v80, v81
    v_cvt_pk_bf16_f32 v165, v82, v83
    v_and_b32 v164, v250, v164
    v_and_b32 v165, v251, v165
    v_mfma_f32_32x32x16_bf16 v[68:83], a[186:189], a[8:11], 0
    v_exp_f32 v52, v52
    v_exp_f32 v53, v53
    v_exp_f32 v54, v54
    v_exp_f32 v55, v55
    v_cvt_pk_bf16_f32 v150, v52, v53
    v_cvt_pk_bf16_f32 v151, v54, v55
    v_mfma_f32_32x32x16_bf16 v[68:83], a[190:193], a[12:15], v[68:83]
    v_exp_f32 v56, v56
    v_exp_f32 v57, v57
    v_exp_f32 v58, v58
    v_exp_f32 v59, v59
    v_cvt_pk_bf16_f32 v152, v56, v57
    v_cvt_pk_bf16_f32 v153, v58, v59
    v_mfma_f32_32x32x16_bf16 v[204:219], a[178:181], v[158:161], v[204:219]
    v_exp_f32 v60, v60
    v_exp_f32 v61, v61
    v_exp_f32 v62, v62
    v_exp_f32 v63, v63
    v_cvt_pk_bf16_f32 v154, v60, v61
    v_cvt_pk_bf16_f32 v155, v62, v63
    v_mfma_f32_32x32x16_bf16 v[204:219], a[182:185], v[162:165], v[204:219]
    v_exp_f32 v64, v64
    v_exp_f32 v65, v65
    v_exp_f32 v66, v66
    v_exp_f32 v67, v67
    v_cvt_pk_bf16_f32 v156, v64, v65
    v_cvt_pk_bf16_f32 v157, v66, v67
    v_mfma_f32_32x32x16_bf16 v[52:67], a[186:189], a[16:19], 0
    v_exp_f32 v68, v68
    v_exp_f32 v69, v69
    v_exp_f32 v70, v70
    v_exp_f32 v71, v71
    v_cvt_pk_bf16_f32 v158, v68, v69
    v_cvt_pk_bf16_f32 v159, v70, v71
    v_mfma_f32_32x32x16_bf16 v[52:67], a[190:193], a[20:23], v[52:67]
    v_exp_f32 v72, v72
    v_exp_f32 v73, v73
    v_exp_f32 v74, v74
    v_exp_f32 v75, v75
    v_cvt_pk_bf16_f32 v160, v72, v73
    v_cvt_pk_bf16_f32 v161, v74, v75
    v_mfma_f32_32x32x16_bf16 v[172:187], a[192:195], v[150:153], v[172:187]
    v_exp_f32 v76, v76
    v_exp_f32 v77, v77
    v_exp_f32 v78, v78
    v_exp_f32 v79, v79
    v_cvt_pk_bf16_f32 v162, v76, v77
    v_cvt_pk_bf16_f32 v163, v78, v79
    v_mfma_f32_32x32x16_bf16 v[172:187], a[196:199], v[154:157], v[172:187]
    v_exp_f32 v80, v80
    v_exp_f32 v81, v81
    v_exp_f32 v82, v82
    v_exp_f32 v83, v83
    v_cvt_pk_bf16_f32 v164, v80, v81
    v_cvt_pk_bf16_f32 v165, v82, v83
    v_mfma_f32_32x32x16_bf16 v[68:83], a[186:189], a[24:27], 0
    v_exp_f32 v52, v52
    v_exp_f32 v53, v53
    v_exp_f32 v54, v54
    v_exp_f32 v55, v55
    s_nop 1
    v_rcp_f32 v84, v182
    v_pk_add_f32 v[86:87], v[172:173], v[174:175]
    v_pk_add_f32 v[88:89], v[176:177], v[178:179]
    v_mov_b32 v85, v84
    v_pk_add_f32 v[86:87], v[86:87], v[180:181]
    v_cvt_pk_bf16_f32 v150, v52, v53
    v_cvt_pk_bf16_f32 v151, v54, v55
    v_mfma_f32_32x32x16_bf16 v[68:83], a[190:193], a[28:31], v[68:83]
    v_exp_f32 v56, v56
    v_exp_f32 v57, v57
    v_exp_f32 v58, v58
    v_exp_f32 v59, v59
    v_pk_add_f32 v[86:87], v[86:87], v[88:89]
    v_pk_mul_f32 v[172:173], v[84:85], v[172:173]
    v_pk_mul_f32 v[174:175], v[84:85], v[174:175]
    v_pk_mul_f32 v[176:177], v[84:85], v[176:177]
    v_pk_mul_f32 v[178:179], v[84:85], v[178:179]
    v_pk_mul_f32 v[180:181], v[84:85], v[180:181]
    v_cvt_pk_bf16_f32 v152, v56, v57
    v_cvt_pk_bf16_f32 v153, v58, v59
    v_mfma_f32_32x32x16_bf16 v[188:203], a[192:195], v[158:161], v[188:203]
    v_exp_f32 v60, v60
    v_exp_f32 v61, v61
    v_exp_f32 v62, v62
    v_exp_f32 v63, v63
    v_add_f32 v86, v86, v87
    v_fma_f32 v86, v86, 0, v182
    v_cvt_pk_bf16_f32 v172, v172, v173
    v_cvt_pk_bf16_f32 v173, v174, v175
    v_cvt_pk_bf16_f32 v174, v176, v177
    v_cvt_pk_bf16_f32 v175, v178, v179
    v_cvt_pk_bf16_f32 v154, v60, v61
    v_cvt_pk_bf16_f32 v155, v62, v63
    v_mfma_f32_32x32x16_bf16 v[188:203], a[196:199], v[162:165], v[188:203]
    v_exp_f32 v64, v64
    v_exp_f32 v65, v65
    v_exp_f32 v66, v66
    v_exp_f32 v67, v67
    v_cvt_pk_bf16_f32 v176, v180, v181
    v_cmp_nle_f32 vcc, v252, v86
    v_cmp_nge_f32 s[4:5], v253, v86
    s_add_u32 s63, s77, 0
    s_add_u32 s64, s78, 0
    s_or_b64 s[74:75], s[74:75], vcc
    v_cvt_pk_bf16_f32 v156, v64, v65
    v_cvt_pk_bf16_f32 v157, v66, v67
    v_exp_f32 v68, v68
    v_exp_f32 v69, v69
    v_exp_f32 v70, v70
    v_exp_f32 v71, v71
    s_or_b64 s[74:75], s[74:75], s[4:5]
    buffer_store_dwordx4 v[172:175], v44, s[20:23], s63 offen sc1
    s_mov_b64 exec, s[56:57]
    buffer_store_dword v176, v47, s[20:23], s64 offen sc1
    s_mov_b64 exec, -1
    s_nop 1
    v_rcp_f32 v84, v198
    v_pk_add_f32 v[86:87], v[188:189], v[190:191]
    v_pk_add_f32 v[88:89], v[192:193], v[194:195]
    v_cvt_pk_bf16_f32 v158, v68, v69
    v_cvt_pk_bf16_f32 v159, v70, v71
    v_and_b32 v158, v244, v158
    v_and_b32 v159, v245, v159
    v_exp_f32 v72, v72
    v_exp_f32 v73, v73
    v_exp_f32 v74, v74
    v_exp_f32 v75, v75
    v_mov_b32 v85, v84
    v_pk_add_f32 v[86:87], v[86:87], v[196:197]
    v_pk_add_f32 v[86:87], v[86:87], v[88:89]
    v_pk_mul_f32 v[188:189], v[84:85], v[188:189]
    v_pk_mul_f32 v[190:191], v[84:85], v[190:191]
    v_pk_mul_f32 v[192:193], v[84:85], v[192:193]
    v_cvt_pk_bf16_f32 v160, v72, v73
    v_cvt_pk_bf16_f32 v161, v74, v75
    v_and_b32 v160, v246, v160
    v_and_b32 v161, v247, v161
    v_mfma_f32_32x32x16_bf16 v[204:219], a[192:195], v[150:153], v[204:219]
    v_exp_f32 v76, v76
    v_exp_f32 v77, v77
    v_exp_f32 v78, v78
    v_exp_f32 v79, v79
    v_pk_mul_f32 v[194:195], v[84:85], v[194:195]
    v_pk_mul_f32 v[196:197], v[84:85], v[196:197]
    v_add_f32 v86, v86, v87
    v_fma_f32 v86, v86, 0, v198
    v_cvt_pk_bf16_f32 v188, v188, v189
    v_cvt_pk_bf16_f32 v189, v190, v191
    v_cvt_pk_bf16_f32 v162, v76, v77
    v_cvt_pk_bf16_f32 v163, v78, v79
    v_and_b32 v162, v248, v162
    v_and_b32 v163, v249, v163
    v_mfma_f32_32x32x16_bf16 v[204:219], a[196:199], v[154:157], v[204:219]
    v_exp_f32 v80, v80
    v_exp_f32 v81, v81
    v_exp_f32 v82, v82
    v_exp_f32 v83, v83
    v_cvt_pk_bf16_f32 v190, v192, v193
    v_cvt_pk_bf16_f32 v191, v194, v195
    v_cvt_pk_bf16_f32 v192, v196, v197
    v_cmp_nle_f32 vcc, v252, v86
    v_cmp_nge_f32 s[4:5], v253, v86
    s_add_u32 s63, s77, 73728
    v_cvt_pk_bf16_f32 v164, v80, v81
    v_cvt_pk_bf16_f32 v165, v82, v83
    v_and_b32 v164, v250, v164
    v_and_b32 v165, v251, v165
    s_add_u32 s64, s78, 73728
    s_or_b64 s[74:75], s[74:75], vcc
    s_or_b64 s[74:75], s[74:75], s[4:5]
    buffer_store_dwordx4 v[188:191], v44, s[20:23], s63 offen sc1
    s_mov_b64 exec, s[56:57]
    buffer_store_dword v192, v47, s[20:23], s64 offen sc1
    s_mov_b64 exec, -1
    s_nop 1
    v_rcp_f32 v84, v214
    v_pk_add_f32 v[86:87], v[204:205], v[206:207]
    v_pk_add_f32 v[88:89], v[208:209], v[210:211]
    v_mov_b32 v85, v84
    v_pk_add_f32 v[86:87], v[86:87], v[212:213]
    v_pk_add_f32 v[86:87], v[86:87], v[88:89]
    v_pk_mul_f32 v[204:205], v[84:85], v[204:205]
    v_pk_mul_f32 v[206:207], v[84:85], v[206:207]
    v_pk_mul_f32 v[208:209], v[84:85], v[208:209]
    v_pk_mul_f32 v[210:211], v[84:85], v[210:211]
    v_pk_mul_f32 v[212:213], v[84:85], v[212:213]
    v_add_f32 v86, v86, v87
    v_fma_f32 v86, v86, 0, v214
    v_cvt_pk_bf16_f32 v204, v204, v205
    v_cvt_pk_bf16_f32 v205, v206, v207
    v_cvt_pk_bf16_f32 v206, v208, v209
    v_cvt_pk_bf16_f32 v207, v210, v211
    v_cvt_pk_bf16_f32 v208, v212, v213
    v_cmp_nle_f32 vcc, v252, v86
    v_cmp_nge_f32 s[4:5], v253, v86
    s_add_u32 s63, s77, 147456
    s_add_u32 s64, s78, 147456
    s_or_b64 s[74:75], s[74:75], vcc
    s_or_b64 s[74:75], s[74:75], s[4:5]
    buffer_store_dwordx4 v[204:207], v44, s[20:23], s63 offen sc1
    s_mov_b64 exec, s[56:57]
    buffer_store_dword v208, v47, s[20:23], s64 offen sc1
    s_mov_b64 exec, -1
    s_nop 1
    v_mfma_f32_32x32x16_bf16 v[220:235], a[192:195], v[158:161], v[220:235]
    v_mfma_f32_32x32x16_bf16 v[220:235], a[196:199], v[162:165], v[220:235]
    s_nop 13
    v_rcp_f32 v84, v230
    v_pk_add_f32 v[86:87], v[220:221], v[222:223]
    v_pk_add_f32 v[88:89], v[224:225], v[226:227]
    v_mov_b32 v85, v84
    v_pk_add_f32 v[86:87], v[86:87], v[228:229]
    v_pk_add_f32 v[86:87], v[86:87], v[88:89]
    v_pk_mul_f32 v[220:221], v[84:85], v[220:221]
    v_pk_mul_f32 v[222:223], v[84:85], v[222:223]
    v_pk_mul_f32 v[224:225], v[84:85], v[224:225]
    v_pk_mul_f32 v[226:227], v[84:85], v[226:227]
    v_pk_mul_f32 v[228:229], v[84:85], v[228:229]
    v_add_f32 v86, v86, v87
    v_fma_f32 v86, v86, 0, v230
    v_cvt_pk_bf16_f32 v220, v220, v221
    v_cvt_pk_bf16_f32 v221, v222, v223
    v_cvt_pk_bf16_f32 v222, v224, v225
    v_cvt_pk_bf16_f32 v223, v226, v227
    v_cvt_pk_bf16_f32 v224, v228, v229
    v_cmp_nle_f32 vcc, v252, v86
    v_cmp_nge_f32 s[4:5], v253, v86
    s_add_u32 s63, s77, 221184
    s_add_u32 s64, s78, 221184
    s_or_b64 s[74:75], s[74:75], vcc
    s_or_b64 s[74:75], s[74:75], s[4:5]
    buffer_store_dwordx4 v[220:223], v44, s[20:23], s63 offen sc1
    s_mov_b64 exec, s[56:57]
    buffer_store_dword v224, v47, s[20:23], s64 offen sc1
    s_mov_b64 exec, -1
    s_or_b32 s4, s74, s75
    s_cmp_eq_u32 s4, 0
    s_cbranch_scc1 L_att_done
    s_cmp_eq_u32 s52, 0
    s_cbranch_scc1 L_slow
L_att_done:
    v_mov_b32 v88, v12
    v_mov_b32 v89, v13
    v_mov_b32 v90, v15
    v_mov_b32 v96, v14
    v_lshrrev_b32 v13, 2, v1
    v_and_b32 v14, 7, v13
    v_lshlrev_b32 v14, 5, v14
    v_lshl_add_u32 v14, v13, 8, v14
    v_and_b32 v15, 3, v1
    v_lshl_add_u32 v14, v15, 3, v14
    v_xor_b32 v2, 0, v14
    v_xor_b32 v3, 32, v14
    v_xor_b32 v4, 64, v14
    v_xor_b32 v5, 96, v14
    v_xor_b32 v6, 128, v14
    v_xor_b32 v7, 160, v14
    v_xor_b32 v8, 192, v14
    v_xor_b32 v9, 224, v14
    v_lshlrev_b32 v13, 5, v13
    v_lshl_add_u32 v13, v15, 3, v13
    v_add_u32 v10, 8192, v13
    v_and_b32 v13, 15, v1
    v_lshrrev_b32 v14, 4, v1
    s_and_b32 s6, s35, 1
    s_lshl_b32 s6, s6, 8
    v_lshl_add_u32 v15, v13, 4, s6
    v_and_b32 v93, 1, v14
    v_lshl_add_u32 v11, v93, 9, v15
    v_lshrrev_b32 v93, 1, v14
    v_mul_u32_u24 v93, 2304, v93
    v_add_u32 v11, v11, v93
    v_lshrrev_b32 v93, 7, v15
    v_lshl_add_u32 v93, v14, 2, v93
    v_mul_u32_u24 v93, 2304, v93
    v_and_b32 v94, 0x70, v15
    v_add_u32 v251, v93, v94
    v_mul_u32_u24 v15, 2304, v13
    v_lshl_add_u32 v12, v14, 3, v15
    s_waitcnt vmcnt(8)
    s_barrier
    ds_read_b64_tr_b16 a[0:1], v2 offset:0
    ds_read_b64_tr_b16 a[2:3], v2 offset:4096
    ds_read_b64_tr_b16 a[4:5], v3 offset:0
    ds_read_b64_tr_b16 a[6:7], v3 offset:4096
    ds_read_b64_tr_b16 a[8:9], v4 offset:0
    ds_read_b64_tr_b16 a[10:11], v4 offset:4096
    ds_read_b64_tr_b16 a[12:13], v5 offset:0
    ds_read_b64_tr_b16 a[14:15], v5 offset:4096
    ds_read_b64_tr_b16 a[16:17], v6 offset:0
    ds_read_b64_tr_b16 a[18:19], v6 offset:4096
    ds_read_b64_tr_b16 a[20:21], v7 offset:0
    ds_read_b64_tr_b16 a[22:23], v7 offset:4096
    ds_read_b64_tr_b16 a[24:25], v8 offset:0
    ds_read_b64_tr_b16 a[26:27], v8 offset:4096
    ds_read_b64_tr_b16 a[28:29], v9 offset:0
    ds_read_b64_tr_b16 a[30:31], v9 offset:4096
    ds_read_b64_tr_b16 a[32:33], v10 offset:0
    ds_read_b64_tr_b16 a[34:35], v10 offset:512
    ds_read_b64_tr_b16 a[36:37], v2 offset:9216
    ds_read_b64_tr_b16 a[38:39], v2 offset:13312
    ds_read_b64_tr_b16 a[40:41], v3 offset:9216
    ds_read_b64_tr_b16 a[42:43], v3 offset:13312
    ds_read_b64_tr_b16 a[44:45], v4 offset:9216
    ds_read_b64_tr_b16 a[46:47], v4 offset:13312
    ds_read_b64_tr_b16 a[48:49], v5 offset:9216
    ds_read_b64_tr_b16 a[50:51], v5 offset:13312
    ds_read_b64_tr_b16 a[52:53], v6 offset:9216
    ds_read_b64_tr_b16 a[54:55], v6 offset:13312
    ds_read_b64_tr_b16 a[56:57], v7 offset:9216
    ds_read_b64_tr_b16 a[58:59], v7 offset:13312
    ds_read_b64_tr_b16 a[60:61], v8 offset:9216
    ds_read_b64_tr_b16 a[62:63], v8 offset:13312
    ds_read_b64_tr_b16 a[64:65], v9 offset:9216
    ds_read_b64_tr_b16 a[66:67], v9 offset:13312
    ds_read_b64_tr_b16 a[68:69], v10 offset:9216
    ds_read_b64_tr_b16 a[70:71], v10 offset:9728
    s_waitcnt lgkmcnt(8)
    ds_read_b64_tr_b16 a[72:73], v2 offset:18432
    ds_read_b64_tr_b16 a[74:75], v2 offset:22528
    ds_read_b64_tr_b16 a[76:77], v3 offset:18432
    ds_read_b64_tr_b16 a[78:79], v3 offset:22528
    ds_read_b64_tr_b16 a[80:81], v4 offset:18432
    ds_read_b64_tr_b16 a[82:83], v4 offset:22528
    ds_read_b64_tr_b16 a[84:85], v5 offset:18432
    ds_read_b64_tr_b16 a[86:87], v5 offset:22528
    ds_read_b64_tr_b16 a[88:89], v6 offset:18432
    ds_read_b64_tr_b16 a[90:91], v6 offset:22528
    ds_read_b64_tr_b16 a[92:93], v7 offset:18432
    ds_read_b64_tr_b16 a[94:95], v7 offset:22528
    ds_read_b64_tr_b16 a[96:97], v8 offset:18432
    ds_read_b64_tr_b16 a[98:99], v8 offset:22528
    ds_read_b64_tr_b16 a[100:101], v9 offset:18432
    ds_read_b64_tr_b16 a[102:103], v9 offset:22528
    ds_read_b64_tr_b16 a[104:105], v10 offset:18432
    ds_read_b64_tr_b16 a[106:107], v10 offset:18944
    s_waitcnt vmcnt(0)
    s_lshl_b32 s63, s34, 2
    s_add_u32 s63, s63, s35
    s_lshl_b32 s63, s63, 7
    s_add_u32 s63, s63, s79
    v_mov_b32 v14, s68
    v_mov_b32 v13, 0
    v_mov_b32 v15, s69
    s_mov_b64 exec, 1
    buffer_store_dwordx2 v[14:15], v13, s[24:27], s63 offen sc1
    s_mov_b64 exec, -1
    ds_read_b64_tr_b16 a[108:109], v2 offset:27648
    ds_read_b64_tr_b16 a[110:111], v2 offset:31744
    ds_read_b64_tr_b16 a[112:113], v3 offset:27648
    ds_read_b64_tr_b16 a[114:115], v3 offset:31744
    ds_read_b64_tr_b16 a[116:117], v4 offset:27648
    ds_read_b64_tr_b16 a[118:119], v4 offset:31744
    ds_read_b64_tr_b16 a[120:121], v5 offset:27648
    ds_read_b64_tr_b16 a[122:123], v5 offset:31744
    ds_read_b64_tr_b16 a[124:125], v6 offset:27648
    ds_read_b64_tr_b16 a[126:127], v6 offset:31744
    ds_read_b64_tr_b16 a[128:129], v7 offset:27648
    ds_read_b64_tr_b16 a[130:131], v7 offset:31744
    ds_read_b64_tr_b16 a[132:133], v8 offset:27648
    ds_read_b64_tr_b16 a[134:135], v8 offset:31744
    ds_read_b64_tr_b16 a[136:137], v9 offset:27648
    ds_read_b64_tr_b16 a[138:139], v9 offset:31744
    ds_read_b64_tr_b16 a[140:141], v10 offset:27648
    ds_read_b64_tr_b16 a[142:143], v10 offset:28160
    s_waitcnt lgkmcnt(8)
    ds_read_b64_tr_b16 a[144:145], v2 offset:36864
    ds_read_b64_tr_b16 a[146:147], v2 offset:40960
    ds_read_b64_tr_b16 a[148:149], v3 offset:36864
    ds_read_b64_tr_b16 a[150:151], v3 offset:40960
    ds_read_b64_tr_b16 a[152:153], v4 offset:36864
    ds_read_b64_tr_b16 a[154:155], v4 offset:40960
    ds_read_b64_tr_b16 a[156:157], v5 offset:36864
    ds_read_b64_tr_b16 a[158:159], v5 offset:40960
    ds_read_b64_tr_b16 a[160:161], v6 offset:36864
    ds_read_b64_tr_b16 a[162:163], v6 offset:40960
    ds_read_b64_tr_b16 a[164:165], v7 offset:36864
    ds_read_b64_tr_b16 a[166:167], v7 offset:40960
    ds_read_b64_tr_b16 a[168:169], v8 offset:36864
    ds_read_b64_tr_b16 a[170:171], v8 offset:40960
    ds_read_b64_tr_b16 a[172:173], v9 offset:36864
    ds_read_b64_tr_b16 a[174:175], v9 offset:40960
    ds_read_b64_tr_b16 a[176:177], v10 offset:36864
    ds_read_b64_tr_b16 a[178:179], v10 offset:37376
    ds_read_b64_tr_b16 a[180:181], v2 offset:46080
    ds_read_b64_tr_b16 a[182:183], v2 offset:50176
    ds_read_b64_tr_b16 a[184:185], v3 offset:46080
    ds_read_b64_tr_b16 a[186:187], v3 offset:50176
    ds_read_b64_tr_b16 a[188:189], v4 offset:46080
    ds_read_b64_tr_b16 a[190:191], v4 offset:50176
    ds_read_b64_tr_b16 a[192:193], v5 offset:46080
    ds_read_b64_tr_b16 a[194:195], v5 offset:50176
    ds_read_b64_tr_b16 a[196:197], v6 offset:46080
    ds_read_b64_tr_b16 a[198:199], v6 offset:50176
    ds_read_b64_tr_b16 a[200:201], v7 offset:46080
    ds_read_b64_tr_b16 a[202:203], v7 offset:50176
    ds_read_b64_tr_b16 a[204:205], v8 offset:46080
    ds_read_b64_tr_b16 a[206:207], v8 offset:50176
    ds_read_b64_tr_b16 a[208:209], v9 offset:46080
    ds_read_b64_tr_b16 a[210:211], v9 offset:50176
    ds_read_b64_tr_b16 a[212:213], v10 offset:46080
    ds_read_b64_tr_b16 a[214:215], v10 offset:46592
    s_waitcnt lgkmcnt(8)
    ds_read_b64_tr_b16 a[216:217], v2 offset:55296
    ds_read_b64_tr_b16 a[218:219], v2 offset:59392
    ds_read_b64_tr_b16 a[220:221], v3 offset:55296
    ds_read_b64_tr_b16 a[222:223], v3 offset:59392
    ds_read_b64_tr_b16 a[224:225], v4 offset:55296
    ds_read_b64_tr_b16 a[226:227], v4 offset:59392
    ds_read_b64_tr_b16 a[228:229], v5 offset:55296
    ds_read_b64_tr_b16 a[230:231], v5 offset:59392
    ds_read_b64_tr_b16 a[232:233], v6 offset:55296
    ds_read_b64_tr_b16 a[234:235], v6 offset:59392
    ds_read_b64_tr_b16 a[236:237], v7 offset:55296
    ds_read_b64_tr_b16 a[238:239], v7 offset:59392
    ds_read_b64_tr_b16 a[240:241], v8 offset:55296
    ds_read_b64_tr_b16 a[242:243], v8 offset:59392
    ds_read_b64_tr_b16 a[244:245], v9 offset:55296
    ds_read_b64_tr_b16 a[246:247], v9 offset:59392
    ds_read_b64_tr_b16 a[248:249], v10 offset:55296
    ds_read_b64_tr_b16 a[250:251], v10 offset:55808
    v_add_u32 v2, 64512, v2
    v_add_u32 v3, 64512, v3
    v_add_u32 v4, 64512, v4
    v_add_u32 v5, 64512, v5
    v_add_u32 v6, 64512, v6
    v_add_u32 v7, 64512, v7
    v_add_u32 v8, 64512, v8
    v_add_u32 v9, 64512, v9
    v_add_u32 v10, 64512, v10
    v_and_b32 v13, 31, v1
    v_lshlrev_b32 v13, 7, v13
    v_mov_b32 v91, s69
    ds_read_b64_tr_b16 v[124:125], v2 offset:0
    ds_read_b64_tr_b16 v[126:127], v2 offset:4096
    ds_read_b64_tr_b16 v[128:129], v3 offset:0
    ds_read_b64_tr_b16 v[130:131], v3 offset:4096
    ds_read_b64_tr_b16 v[132:133], v4 offset:0
    ds_read_b64_tr_b16 v[134:135], v4 offset:4096
    ds_read_b64_tr_b16 v[136:137], v5 offset:0
    ds_read_b64_tr_b16 v[138:139], v5 offset:4096
    ds_read_b64_tr_b16 v[140:141], v6 offset:0
    ds_read_b64_tr_b16 v[142:143], v6 offset:4096
    ds_read_b64_tr_b16 v[144:145], v7 offset:0
    ds_read_b64_tr_b16 v[146:147], v7 offset:4096
    ds_read_b64_tr_b16 v[148:149], v8 offset:0
    ds_read_b64_tr_b16 v[150:151], v8 offset:4096
    ds_read_b64_tr_b16 v[152:153], v9 offset:0
    ds_read_b64_tr_b16 v[154:155], v9 offset:4096
    ds_read_b64_tr_b16 v[156:157], v10 offset:0
    ds_read_b64_tr_b16 v[158:159], v10 offset:512
    ds_read_b64_tr_b16 v[160:161], v2 offset:9216
    ds_read_b64_tr_b16 v[162:163], v2 offset:13312
    ds_read_b64_tr_b16 v[164:165], v3 offset:9216
    ds_read_b64_tr_b16 v[166:167], v3 offset:13312
    ds_read_b64_tr_b16 v[168:169], v4 offset:9216
    ds_read_b64_tr_b16 v[170:171], v4 offset:13312
    ds_read_b64_tr_b16 v[172:173], v5 offset:9216
    ds_read_b64_tr_b16 v[174:175], v5 offset:13312
    ds_read_b64_tr_b16 v[176:177], v6 offset:9216
    ds_read_b64_tr_b16 v[178:179], v6 offset:13312
    ds_read_b64_tr_b16 v[180:181], v7 offset:9216
    ds_read_b64_tr_b16 v[182:183], v7 offset:13312
    ds_read_b64_tr_b16 v[184:185], v8 offset:9216
    ds_read_b64_tr_b16 v[186:187], v8 offset:13312
    ds_read_b64_tr_b16 v[188:189], v9 offset:9216
    ds_read_b64_tr_b16 v[190:191], v9 offset:13312
    ds_read_b64_tr_b16 v[192:193], v10 offset:9216
    ds_read_b64_tr_b16 v[194:195], v10 offset:9728
    ds_read_b64_tr_b16 v[196:197], v2 offset:18432
    ds_read_b64_tr_b16 v[198:199], v2 offset:22528
    ds_read_b64_tr_b16 v[200:201], v3 offset:18432
    ds_read_b64_tr_b16 v[202:203], v3 offset:22528
    ds_read_b64_tr_b16 v[204:205], v4 offset:18432
    ds_read_b64_tr_b16 v[206:207], v4 offset:22528
    ds_read_b64_tr_b16 v[208:209], v5 offset:18432
    ds_read_b64_tr_b16 v[210:211], v5 offset:22528
    ds_read_b64_tr_b16 v[212:213], v6 offset:18432
    ds_read_b64_tr_b16 v[214:215], v6 offset:22528
    ds_read_b64_tr_b16 v[216:217], v7 offset:18432
    ds_read_b64_tr_b16 v[218:219], v7 offset:22528
    ds_read_b64_tr_b16 v[220:221], v8 offset:18432
    ds_read_b64_tr_b16 v[222:223], v8 offset:22528
    ds_read_b64_tr_b16 v[224:225], v9 offset:18432
    ds_read_b64_tr_b16 v[226:227], v9 offset:22528
    ds_read_b64_tr_b16 v[228:229], v10 offset:18432
    ds_read_b64_tr_b16 v[230:231], v10 offset:18944
    v_and_b32 v252, 15, v1
    v_mul_u32_u24 v252, 304, v252
    v_lshrrev_b32 v253, 4, v1
    v_lshl_add_u32 v252, v253, 3, v252
    s_mul_i32 s65, s35, 4864
    s_add_u32 s65, s65, 9216
    v_add_u32 v250, s65, v252
    v_add_u32 v252, 0, v1
    v_mul_u32_u24 v253, 58255, v252
    v_lshrrev_b32 v253, 20, v253
    v_mul_u32_u24 v254, 18, v253
    v_sub_u32 v254, v252, v254
    v_lshlrev_b32 v254, 4, v254
    v_mul_u32_u24 v252, 304, v253
    v_add3_u32 v240, v252, v254, s65
    v_mul_u32_u24 v252, 2304, v253
    v_add_u32 v245, v252, v254
    v_add_u32 v252, 64, v1
    v_mul_u32_u24 v253, 58255, v252
    v_lshrrev_b32 v253, 20, v253
    v_mul_u32_u24 v254, 18, v253
    v_sub_u32 v254, v252, v254
    v_lshlrev_b32 v254, 4, v254
    v_mul_u32_u24 v252, 304, v253
    v_add3_u32 v241, v252, v254, s65
    v_mul_u32_u24 v252, 2304, v253
    v_add_u32 v246, v252, v254
    v_add_u32 v252, 128, v1
    v_mul_u32_u24 v253, 58255, v252
    v_lshrrev_b32 v253, 20, v253
    v_mul_u32_u24 v254, 18, v253
    v_sub_u32 v254, v252, v254
    v_lshlrev_b32 v254, 4, v254
    v_mul_u32_u24 v252, 304, v253
    v_add3_u32 v242, v252, v254, s65
    v_mul_u32_u24 v252, 2304, v253
    v_add_u32 v247, v252, v254
    v_add_u32 v252, 192, v1
    v_mul_u32_u24 v253, 58255, v252
    v_lshrrev_b32 v253, 20, v253
    v_mul_u32_u24 v254, 18, v253
    v_sub_u32 v254, v252, v254
    v_lshlrev_b32 v254, 4, v254
    v_mul_u32_u24 v252, 304, v253
    v_add3_u32 v243, v252, v254, s65
    v_mul_u32_u24 v252, 2304, v253
    v_add_u32 v248, v252, v254
    v_add_u32 v252, 256, v1
    v_mul_u32_u24 v253, 58255, v252
    v_lshrrev_b32 v253, 20, v253
    v_mul_u32_u24 v254, 18, v253
    v_sub_u32 v254, v252, v254
    v_lshlrev_b32 v254, 4, v254
    v_mul_u32_u24 v252, 304, v253
    v_add3_u32 v244, v252, v254, s65
    v_mul_u32_u24 v252, 2304, v253
    v_add_u32 v249, v252, v254
    s_waitcnt lgkmcnt(0)
    s_barrier
    s_lshl_b32 s64, s35, 1
    s_and_b32 s64, s64, 3
    s_lshl_b32 s64, s64, 2
    s_lshr_b32 s65, s35, 1
    s_lshl_b32 s65, s65, 1
    s_add_u32 s64, s64, s65
    s_mul_i32 s64, s64, 20736
    s_add_u32 s65, s64, 350208
    s_lshl_b32 s64, s35, 11
    s_add_u32 m0, s64, 0
    s_nop 0
    buffer_load_dwordx4 v88, s[16:19], s65 offen lds
    s_add_u32 s65, s65, 81920
    buffer_load_dwordx4 v89, s[16:19], s65 offen offset:1024 lds
    s_mov_b32 s65, 331776
    s_mov_b32 m0, 8192
    s_nop 0
    buffer_load_dwordx4 v90, s[16:19], s65 offen lds
    s_cmp_lg_u32 s35, 0
    s_cbranch_scc1 L_opoll_done
    s_mov_b64 exec, s[56:57]
    buffer_load_dwordx2 v[14:15], v13, s[24:27], s79 offen sc1
    s_mov_b64 exec, -1
    s_waitcnt vmcnt(0)
    s_mov_b32 s76, 200000
L_opoll:
    s_mov_b64 exec, s[56:57]
    v_cmp_eq_u32 vcc, s68, v14
    v_cmp_eq_u32 s[4:5], v91, v15
    s_mov_b64 exec, -1
    s_and_b64 s[4:5], s[4:5], vcc
    s_or_b32 s4, s4, s5
    s_cmp_eq_u32 s4, -1
    s_cbranch_scc1 L_opoll_done
    s_mov_b64 exec, s[56:57]
    buffer_load_dwordx2 v[14:15], v13, s[24:27], s79 offen sc1
    s_mov_b64 exec, -1
    s_waitcnt vmcnt(0)
    s_sub_u32 s76, s76, 1
    s_cmp_lg_u32 s76, 0
    s_cbranch_scc1 L_opoll
L_opoll_done:
    s_waitcnt vmcnt(0)
    s_barrier
    s_add_u32 s63, s84, 32256
    buffer_load_dwordx4 v[44:47], v11, s[20:23], s63 offen sc1
    s_add_u32 s63, s84, 0
    buffer_load_dwordx4 v[16:19], v11, s[20:23], s63 offen sc1
    s_add_u32 s63, s84, 36864
    buffer_load_dwordx4 v[48:51], v11, s[20:23], s63 offen sc1
    s_add_u32 s63, s84, 4608
    buffer_load_dwordx4 v[20:23], v11, s[20:23], s63 offen sc1
    s_add_u32 s63, s84, 41472
    buffer_load_dwordx4 v[52:55], v11, s[20:23], s63 offen sc1
    s_add_u32 s63, s84, 9216
    buffer_load_dwordx4 v[24:27], v11, s[20:23], s63 offen sc1
    s_add_u32 s63, s84, 46080
    buffer_load_dwordx4 v[56:59], v11, s[20:23], s63 offen sc1
    s_waitcnt vmcnt(6)
    v_mfma_f32_16x16x32_bf16 v[88:91], v[124:127], v[44:47], 0
    ds_read_b64_tr_b16 v[232:233], v2 offset:27648
    ds_read_b64_tr_b16 v[234:235], v2 offset:31744
    v_mfma_f32_16x16x32_bf16 v[92:95], v[128:131], v[44:47], 0
    ds_read_b64_tr_b16 v[236:237], v3 offset:27648
    ds_read_b64_tr_b16 v[238:239], v3 offset:31744
    v_mfma_f32_16x16x32_bf16 v[96:99], v[132:135], v[44:47], 0
    ds_read_b64_tr_b16 v[124:125], v4 offset:27648
    ds_read_b64_tr_b16 v[126:127], v4 offset:31744
    v_mfma_f32_16x16x32_bf16 v[100:103], v[136:139], v[44:47], 0
    s_add_u32 s63, s84, 13824
    buffer_load_dwordx4 v[28:31], v11, s[20:23], s63 offen sc1
    ds_read_b64_tr_b16 v[128:129], v5 offset:27648
    ds_read_b64_tr_b16 v[130:131], v5 offset:31744
    v_mfma_f32_16x16x32_bf16 v[104:107], v[140:143], v[44:47], 0
    ds_read_b64_tr_b16 v[132:133], v6 offset:27648
    ds_read_b64_tr_b16 v[134:135], v6 offset:31744
    v_mfma_f32_16x16x32_bf16 v[108:111], v[144:147], v[44:47], 0
    ds_read_b64_tr_b16 v[136:137], v7 offset:27648
    ds_read_b64_tr_b16 v[138:139], v7 offset:31744
    v_mfma_f32_16x16x32_bf16 v[112:115], v[148:151], v[44:47], 0
    ds_read_b64_tr_b16 v[140:141], v8 offset:27648
    ds_read_b64_tr_b16 v[142:143], v8 offset:31744
    v_mfma_f32_16x16x32_bf16 v[116:119], v[152:155], v[44:47], 0
    s_add_u32 s63, s84, 50688
    buffer_load_dwordx4 v[60:63], v11, s[20:23], s63 offen sc1
    ds_read_b64_tr_b16 v[144:145], v9 offset:27648
    ds_read_b64_tr_b16 v[146:147], v9 offset:31744
    v_mfma_f32_16x16x32_bf16 v[120:123], v[156:159], v[44:47], 0
    ds_read_b64_tr_b16 v[148:149], v10 offset:27648
    ds_read_b64_tr_b16 v[150:151], v10 offset:28160
    s_waitcnt vmcnt(7)
    v_mfma_f32_16x16x32_bf16 v[88:91], a[0:3], v[16:19], v[88:91]
    ds_read_b64_tr_b16 v[152:153], v2 offset:36864
    ds_read_b64_tr_b16 v[154:155], v2 offset:40960
    v_mfma_f32_16x16x32_bf16 v[92:95], a[4:7], v[16:19], v[92:95]
    v_mfma_f32_16x16x32_bf16 v[96:99], a[8:11], v[16:19], v[96:99]
    s_add_u32 s63, s84, 18432
    buffer_load_dwordx4 v[32:35], v11, s[20:23], s63 offen sc1
    v_mfma_f32_16x16x32_bf16 v[100:103], a[12:15], v[16:19], v[100:103]
    v_mfma_f32_16x16x32_bf16 v[104:107], a[16:19], v[16:19], v[104:107]
    v_mfma_f32_16x16x32_bf16 v[108:111], a[20:23], v[16:19], v[108:111]
    v_mfma_f32_16x16x32_bf16 v[112:115], a[24:27], v[16:19], v[112:115]
    s_add_u32 s63, s84, 55296
    buffer_load_dwordx4 v[64:67], v11, s[20:23], s63 offen sc1
    v_mfma_f32_16x16x32_bf16 v[116:119], a[28:31], v[16:19], v[116:119]
    v_mfma_f32_16x16x32_bf16 v[120:123], a[32:35], v[16:19], v[120:123]
    s_waitcnt vmcnt(8)
    v_mfma_f32_16x16x32_bf16 v[88:91], v[160:163], v[48:51], v[88:91]
    ds_read_b64_tr_b16 v[156:157], v3 offset:36864
    ds_read_b64_tr_b16 v[158:159], v3 offset:40960
    v_mfma_f32_16x16x32_bf16 v[92:95], v[164:167], v[48:51], v[92:95]
    s_add_u32 s63, s84, 23040
    buffer_load_dwordx4 v[36:39], v11, s[20:23], s63 offen sc1
    ds_read_b64_tr_b16 v[160:161], v4 offset:36864
    ds_read_b64_tr_b16 v[162:163], v4 offset:40960
    v_mfma_f32_16x16x32_bf16 v[96:99], v[168:171], v[48:51], v[96:99]
    ds_read_b64_tr_b16 v[164:165], v5 offset:36864
    ds_read_b64_tr_b16 v[166:167], v5 offset:40960
    v_mfma_f32_16x16x32_bf16 v[100:103], v[172:175], v[48:51], v[100:103]
    ds_read_b64_tr_b16 v[168:169], v6 offset:36864
    ds_read_b64_tr_b16 v[170:171], v6 offset:40960
    v_mfma_f32_16x16x32_bf16 v[104:107], v[176:179], v[48:51], v[104:107]
    ds_read_b64_tr_b16 v[172:173], v7 offset:36864
    ds_read_b64_tr_b16 v[174:175], v7 offset:40960
    v_mfma_f32_16x16x32_bf16 v[108:111], v[180:183], v[48:51], v[108:111]
    s_add_u32 s63, s84, 59904
    buffer_load_dwordx4 v[68:71], v11, s[20:23], s63 offen sc1
    ds_read_b64_tr_b16 v[176:177], v8 offset:36864
    ds_read_b64_tr_b16 v[178:179], v8 offset:40960
    v_mfma_f32_16x16x32_bf16 v[112:115], v[184:187], v[48:51], v[112:115]
    ds_read_b64_tr_b16 v[180:181], v9 offset:36864
    ds_read_b64_tr_b16 v[182:183], v9 offset:40960
    v_mfma_f32_16x16x32_bf16 v[116:119], v[188:191], v[48:51], v[116:119]
    ds_read_b64_tr_b16 v[184:185], v10 offset:36864
    ds_read_b64_tr_b16 v[186:187], v10 offset:37376
    v_mfma_f32_16x16x32_bf16 v[120:123], v[192:195], v[48:51], v[120:123]
    ds_read_b64_tr_b16 v[188:189], v2 offset:46080
    ds_read_b64_tr_b16 v[190:191], v2 offset:50176
    s_waitcnt vmcnt(9)
    v_mfma_f32_16x16x32_bf16 v[88:91], a[36:39], v[20:23], v[88:91]
    s_add_u32 s63, s84, 27648
    buffer_load_dwordx4 v[40:43], v11, s[20:23], s63 offen sc1
    v_mfma_f32_16x16x32_bf16 v[92:95], a[40:43], v[20:23], v[92:95]
    v_mfma_f32_16x16x32_bf16 v[96:99], a[44:47], v[20:23], v[96:99]
    v_mfma_f32_16x16x32_bf16 v[100:103], a[48:51], v[20:23], v[100:103]
    v_mfma_f32_16x16x32_bf16 v[104:107], a[52:55], v[20:23], v[104:107]
    s_add_u32 s63, s84, 64512
    buffer_load_dwordx4 v[72:75], v11, s[20:23], s63 offen sc1
    v_mfma_f32_16x16x32_bf16 v[108:111], a[56:59], v[20:23], v[108:111]
    v_mfma_f32_16x16x32_bf16 v[112:115], a[60:63], v[20:23], v[112:115]
    v_mfma_f32_16x16x32_bf16 v[116:119], a[64:67], v[20:23], v[116:119]
    v_mfma_f32_16x16x32_bf16 v[120:123], a[68:71], v[20:23], v[120:123]
    s_add_u32 s63, s84, 69120
    buffer_load_dwordx4 v[76:79], v11, s[20:23], s63 offen sc1
    s_waitcnt vmcnt(11)
    v_mfma_f32_16x16x32_bf16 v[88:91], v[196:199], v[52:55], v[88:91]
    ds_read_b64_tr_b16 v[192:193], v3 offset:46080
    ds_read_b64_tr_b16 v[194:195], v3 offset:50176
    v_mfma_f32_16x16x32_bf16 v[92:95], v[200:203], v[52:55], v[92:95]
    ds_read_b64_tr_b16 v[196:197], v4 offset:46080
    ds_read_b64_tr_b16 v[198:199], v4 offset:50176
    v_mfma_f32_16x16x32_bf16 v[96:99], v[204:207], v[52:55], v[96:99]
    ds_read_b64_tr_b16 v[200:201], v5 offset:46080
    ds_read_b64_tr_b16 v[202:203], v5 offset:50176
    v_mfma_f32_16x16x32_bf16 v[100:103], v[208:211], v[52:55], v[100:103]
    s_add_u32 s63, s85, 0
    buffer_load_dwordx4 v[80:83], v251, s[20:23], s63 offen sc1
    ds_read_b64_tr_b16 v[204:205], v6 offset:46080
    ds_read_b64_tr_b16 v[206:207], v6 offset:50176
    v_mfma_f32_16x16x32_bf16 v[104:107], v[212:215], v[52:55], v[104:107]
    ds_read_b64_tr_b16 v[208:209], v7 offset:46080
    ds_read_b64_tr_b16 v[210:211], v7 offset:50176
    v_mfma_f32_16x16x32_bf16 v[108:111], v[216:219], v[52:55], v[108:111]
    ds_read_b64_tr_b16 v[212:213], v8 offset:46080
    ds_read_b64_tr_b16 v[214:215], v8 offset:50176
    v_mfma_f32_16x16x32_bf16 v[112:115], v[220:223], v[52:55], v[112:115]
    ds_read_b64_tr_b16 v[216:217], v9 offset:46080
    ds_read_b64_tr_b16 v[218:219], v9 offset:50176
    v_mfma_f32_16x16x32_bf16 v[116:119], v[224:227], v[52:55], v[116:119]
    s_add_u32 s63, s85, 36864
    buffer_load_dwordx4 v[84:87], v251, s[20:23], s63 offen sc1
    ds_read_b64_tr_b16 v[220:221], v10 offset:46080
    ds_read_b64_tr_b16 v[222:223], v10 offset:46592
    v_mfma_f32_16x16x32_bf16 v[120:123], v[228:231], v[52:55], v[120:123]
    ds_read_b64_tr_b16 v[224:225], v2 offset:55296
    ds_read_b64_tr_b16 v[226:227], v2 offset:59392
    s_waitcnt vmcnt(12)
    v_mfma_f32_16x16x32_bf16 v[88:91], a[72:75], v[24:27], v[88:91]
    v_mfma_f32_16x16x32_bf16 v[92:95], a[76:79], v[24:27], v[92:95]
    v_mfma_f32_16x16x32_bf16 v[96:99], a[80:83], v[24:27], v[96:99]
    v_mfma_f32_16x16x32_bf16 v[100:103], a[84:87], v[24:27], v[100:103]
    v_mfma_f32_16x16x32_bf16 v[104:107], a[88:91], v[24:27], v[104:107]
    v_mfma_f32_16x16x32_bf16 v[108:111], a[92:95], v[24:27], v[108:111]
    v_mfma_f32_16x16x32_bf16 v[112:115], a[96:99], v[24:27], v[112:115]
    v_mfma_f32_16x16x32_bf16 v[116:119], a[100:103], v[24:27], v[116:119]
    v_mfma_f32_16x16x32_bf16 v[120:123], a[104:107], v[24:27], v[120:123]
    s_waitcnt vmcnt(11)
    s_waitcnt lgkmcnt(15)
    v_mfma_f32_16x16x32_bf16 v[88:91], v[232:235], v[56:59], v[88:91]
    ds_read_b64_tr_b16 v[228:229], v3 offset:55296
    ds_read_b64_tr_b16 v[230:231], v3 offset:59392
    s_waitcnt lgkmcnt(15)
    v_mfma_f32_16x16x32_bf16 v[92:95], v[236:239], v[56:59], v[92:95]
    ds_read_b64_tr_b16 v[232:233], v4 offset:55296
    ds_read_b64_tr_b16 v[234:235], v4 offset:59392
    s_waitcnt lgkmcnt(15)
    v_mfma_f32_16x16x32_bf16 v[96:99], v[124:127], v[56:59], v[96:99]
    ds_read_b64_tr_b16 v[236:237], v5 offset:55296
    ds_read_b64_tr_b16 v[238:239], v5 offset:59392
    s_waitcnt lgkmcnt(15)
    v_mfma_f32_16x16x32_bf16 v[100:103], v[128:131], v[56:59], v[100:103]
    ds_read_b64_tr_b16 v[124:125], v6 offset:55296
    ds_read_b64_tr_b16 v[126:127], v6 offset:59392
    s_waitcnt lgkmcnt(15)
    v_mfma_f32_16x16x32_bf16 v[104:107], v[132:135], v[56:59], v[104:107]
    ds_read_b64_tr_b16 v[128:129], v7 offset:55296
    ds_read_b64_tr_b16 v[130:131], v7 offset:59392
    s_waitcnt lgkmcnt(15)
    v_mfma_f32_16x16x32_bf16 v[108:111], v[136:139], v[56:59], v[108:111]
    ds_read_b64_tr_b16 v[132:133], v8 offset:55296
    ds_read_b64_tr_b16 v[134:135], v8 offset:59392
    s_waitcnt lgkmcnt(15)
    v_mfma_f32_16x16x32_bf16 v[112:115], v[140:143], v[56:59], v[112:115]
    ds_read_b64_tr_b16 v[136:137], v9 offset:55296
    ds_read_b64_tr_b16 v[138:139], v9 offset:59392
    s_waitcnt lgkmcnt(15)
    v_mfma_f32_16x16x32_bf16 v[116:119], v[144:147], v[56:59], v[116:119]
    ds_read_b64_tr_b16 v[140:141], v10 offset:55296
    ds_read_b64_tr_b16 v[142:143], v10 offset:55808
    s_waitcnt lgkmcnt(15)
    v_mfma_f32_16x16x32_bf16 v[120:123], v[148:151], v[56:59], v[120:123]
    v_add_u32 v2, 64512, v2
    v_add_u32 v3, 64512, v3
    v_add_u32 v4, 64512, v4
    v_add_u32 v5, 64512, v5
    v_add_u32 v6, 64512, v6
    v_add_u32 v7, 64512, v7
    v_add_u32 v8, 64512, v8
    v_add_u32 v9, 64512, v9
    v_add_u32 v10, 64512, v10
    ds_read_b64_tr_b16 v[144:145], v2 offset:0
    ds_read_b64_tr_b16 v[146:147], v2 offset:4096
    s_waitcnt vmcnt(10)
    v_mfma_f32_16x16x32_bf16 v[88:91], a[108:111], v[28:31], v[88:91]
    v_mfma_f32_16x16x32_bf16 v[92:95], a[112:115], v[28:31], v[92:95]
    v_mfma_f32_16x16x32_bf16 v[96:99], a[116:119], v[28:31], v[96:99]
    v_mfma_f32_16x16x32_bf16 v[100:103], a[120:123], v[28:31], v[100:103]
    v_mfma_f32_16x16x32_bf16 v[104:107], a[124:127], v[28:31], v[104:107]
    v_mfma_f32_16x16x32_bf16 v[108:111], a[128:131], v[28:31], v[108:111]
    v_mfma_f32_16x16x32_bf16 v[112:115], a[132:135], v[28:31], v[112:115]
    v_mfma_f32_16x16x32_bf16 v[116:119], a[136:139], v[28:31], v[116:119]
    v_mfma_f32_16x16x32_bf16 v[120:123], a[140:143], v[28:31], v[120:123]
    s_waitcnt vmcnt(9)
    s_waitcnt lgkmcnt(15)
    v_mfma_f32_16x16x32_bf16 v[88:91], v[152:155], v[60:63], v[88:91]
    ds_read_b64_tr_b16 v[148:149], v3 offset:0
    ds_read_b64_tr_b16 v[150:151], v3 offset:4096
    s_waitcnt lgkmcnt(15)
    v_mfma_f32_16x16x32_bf16 v[92:95], v[156:159], v[60:63], v[92:95]
    ds_read_b64_tr_b16 v[152:153], v4 offset:0
    ds_read_b64_tr_b16 v[154:155], v4 offset:4096
    s_waitcnt lgkmcnt(15)
    v_mfma_f32_16x16x32_bf16 v[96:99], v[160:163], v[60:63], v[96:99]
    ds_read_b64_tr_b16 v[156:157], v5 offset:0
    ds_read_b64_tr_b16 v[158:159], v5 offset:4096
    s_waitcnt lgkmcnt(15)
    v_mfma_f32_16x16x32_bf16 v[100:103], v[164:167], v[60:63], v[100:103]
    ds_read_b64_tr_b16 v[160:161], v6 offset:0
    ds_read_b64_tr_b16 v[162:163], v6 offset:4096
    s_waitcnt lgkmcnt(15)
    v_mfma_f32_16x16x32_bf16 v[104:107], v[168:171], v[60:63], v[104:107]
    ds_read_b64_tr_b16 v[164:165], v7 offset:0
    ds_read_b64_tr_b16 v[166:167], v7 offset:4096
    s_waitcnt lgkmcnt(15)
    v_mfma_f32_16x16x32_bf16 v[108:111], v[172:175], v[60:63], v[108:111]
    ds_read_b64_tr_b16 v[168:169], v8 offset:0
    ds_read_b64_tr_b16 v[170:171], v8 offset:4096
    s_waitcnt lgkmcnt(15)
    v_mfma_f32_16x16x32_bf16 v[112:115], v[176:179], v[60:63], v[112:115]
    ds_read_b64_tr_b16 v[172:173], v9 offset:0
    ds_read_b64_tr_b16 v[174:175], v9 offset:4096
    s_waitcnt lgkmcnt(15)
    v_mfma_f32_16x16x32_bf16 v[116:119], v[180:183], v[60:63], v[116:119]
    ds_read_b64_tr_b16 v[176:177], v10 offset:0
    ds_read_b64_tr_b16 v[178:179], v10 offset:512
    s_waitcnt lgkmcnt(15)
    v_mfma_f32_16x16x32_bf16 v[120:123], v[184:187], v[60:63], v[120:123]
    ds_read_b64_tr_b16 v[180:181], v2 offset:9216
    ds_read_b64_tr_b16 v[182:183], v2 offset:13312
    s_waitcnt vmcnt(8)
    v_mfma_f32_16x16x32_bf16 v[88:91], a[144:147], v[32:35], v[88:91]
    v_mfma_f32_16x16x32_bf16 v[92:95], a[148:151], v[32:35], v[92:95]
    v_mfma_f32_16x16x32_bf16 v[96:99], a[152:155], v[32:35], v[96:99]
    v_mfma_f32_16x16x32_bf16 v[100:103], a[156:159], v[32:35], v[100:103]
    v_mfma_f32_16x16x32_bf16 v[104:107], a[160:163], v[32:35], v[104:107]
    v_mfma_f32_16x16x32_bf16 v[108:111], a[164:167], v[32:35], v[108:111]
    v_mfma_f32_16x16x32_bf16 v[112:115], a[168:171], v[32:35], v[112:115]
    v_mfma_f32_16x16x32_bf16 v[116:119], a[172:175], v[32:35], v[116:119]
    v_mfma_f32_16x16x32_bf16 v[120:123], a[176:179], v[32:35], v[120:123]
    s_waitcnt vmcnt(7)
    s_waitcnt lgkmcnt(15)
    v_mfma_f32_16x16x32_bf16 v[88:91], v[188:191], v[64:67], v[88:91]
    ds_read_b64_tr_b16 v[184:185], v3 offset:9216
    ds_read_b64_tr_b16 v[186:187], v3 offset:13312
    s_waitcnt lgkmcnt(15)
    v_mfma_f32_16x16x32_bf16 v[92:95], v[192:195], v[64:67], v[92:95]
    ds_read_b64_tr_b16 v[188:189], v4 offset:9216
    ds_read_b64_tr_b16 v[190:191], v4 offset:13312
    s_waitcnt lgkmcnt(15)
    v_mfma_f32_16x16x32_bf16 v[96:99], v[196:199], v[64:67], v[96:99]
    ds_read_b64_tr_b16 v[192:193], v5 offset:9216
    ds_read_b64_tr_b16 v[194:195], v5 offset:13312
    s_waitcnt lgkmcnt(15)
    v_mfma_f32_16x16x32_bf16 v[100:103], v[200:203], v[64:67], v[100:103]
    ds_read_b64_tr_b16 v[196:197], v6 offset:9216
    ds_read_b64_tr_b16 v[198:199], v6 offset:13312
    s_waitcnt lgkmcnt(15)
    v_mfma_f32_16x16x32_bf16 v[104:107], v[204:207], v[64:67], v[104:107]
    ds_read_b64_tr_b16 v[200:201], v7 offset:9216
    ds_read_b64_tr_b16 v[202:203], v7 offset:13312
    s_waitcnt lgkmcnt(15)
    v_mfma_f32_16x16x32_bf16 v[108:111], v[208:211], v[64:67], v[108:111]
    ds_read_b64_tr_b16 v[204:205], v8 offset:9216
    ds_read_b64_tr_b16 v[206:207], v8 offset:13312
    s_waitcnt lgkmcnt(15)
    v_mfma_f32_16x16x32_bf16 v[112:115], v[212:215], v[64:67], v[112:115]
    ds_read_b64_tr_b16 v[208:209], v9 offset:9216
    ds_read_b64_tr_b16 v[210:211], v9 offset:13312
    s_waitcnt lgkmcnt(15)
    v_mfma_f32_16x16x32_bf16 v[116:119], v[216:219], v[64:67], v[116:119]
    ds_read_b64_tr_b16 v[212:213], v10 offset:9216
    ds_read_b64_tr_b16 v[214:215], v10 offset:9728
    s_waitcnt lgkmcnt(15)
    v_mfma_f32_16x16x32_bf16 v[120:123], v[220:223], v[64:67], v[120:123]
    ds_read_b64_tr_b16 v[216:217], v2 offset:18432
    ds_read_b64_tr_b16 v[218:219], v2 offset:22528
    s_waitcnt vmcnt(6)
    v_mfma_f32_16x16x32_bf16 v[88:91], a[180:183], v[36:39], v[88:91]
    s_waitcnt vmcnt(0)
    s_lshl_b32 s63, s34, 2
    s_add_u32 s63, s63, s35
    s_lshl_b32 s63, s63, 7
    s_add_u32 s63, s63, s79
    v_mov_b32 v252, s68
    v_mov_b32 v254, 0
    s_add_u32 s63, s63, 786432
    v_mov_b32 v253, s69
    s_mov_b64 exec, 1
    buffer_store_dwordx2 v[252:253], v254, s[24:27], s63 offen sc1
    s_mov_b64 exec, -1
    v_mfma_f32_16x16x32_bf16 v[92:95], a[184:187], v[36:39], v[92:95]
    v_mfma_f32_16x16x32_bf16 v[96:99], a[188:191], v[36:39], v[96:99]
    v_mfma_f32_16x16x32_bf16 v[100:103], a[192:195], v[36:39], v[100:103]
    v_mfma_f32_16x16x32_bf16 v[104:107], a[196:199], v[36:39], v[104:107]
    v_mfma_f32_16x16x32_bf16 v[108:111], a[200:203], v[36:39], v[108:111]
    v_mfma_f32_16x16x32_bf16 v[112:115], a[204:207], v[36:39], v[112:115]
    v_mfma_f32_16x16x32_bf16 v[116:119], a[208:211], v[36:39], v[116:119]
    v_mfma_f32_16x16x32_bf16 v[120:123], a[212:215], v[36:39], v[120:123]
    s_waitcnt vmcnt(6)
    s_waitcnt lgkmcnt(15)
    v_mfma_f32_16x16x32_bf16 v[88:91], v[224:227], v[68:71], v[88:91]
    ds_read_b64_tr_b16 v[220:221], v3 offset:18432
    ds_read_b64_tr_b16 v[222:223], v3 offset:22528
    s_waitcnt lgkmcnt(15)
    v_mfma_f32_16x16x32_bf16 v[92:95], v[228:231], v[68:71], v[92:95]
    ds_read_b64_tr_b16 v[224:225], v4 offset:18432
    ds_read_b64_tr_b16 v[226:227], v4 offset:22528
    s_waitcnt lgkmcnt(15)
    v_mfma_f32_16x16x32_bf16 v[96:99], v[232:235], v[68:71], v[96:99]
    ds_read_b64_tr_b16 v[228:229], v5 offset:18432
    ds_read_b64_tr_b16 v[230:231], v5 offset:22528
    s_waitcnt lgkmcnt(15)
    v_mfma_f32_16x16x32_bf16 v[100:103], v[236:239], v[68:71], v[100:103]
    ds_read_b64_tr_b16 v[232:233], v6 offset:18432
    ds_read_b64_tr_b16 v[234:235], v6 offset:22528
    s_waitcnt lgkmcnt(15)
    v_mfma_f32_16x16x32_bf16 v[104:107], v[124:127], v[68:71], v[104:107]
    ds_read_b64_tr_b16 v[236:237], v7 offset:18432
    ds_read_b64_tr_b16 v[238:239], v7 offset:22528
    s_waitcnt lgkmcnt(15)
    v_mfma_f32_16x16x32_bf16 v[108:111], v[128:131], v[68:71], v[108:111]
    ds_read_b64_tr_b16 v[124:125], v8 offset:18432
    ds_read_b64_tr_b16 v[126:127], v8 offset:22528
    s_waitcnt lgkmcnt(15)
    v_mfma_f32_16x16x32_bf16 v[112:115], v[132:135], v[68:71], v[112:115]
    ds_read_b64_tr_b16 v[128:129], v9 offset:18432
    ds_read_b64_tr_b16 v[130:131], v9 offset:22528
    s_waitcnt lgkmcnt(15)
    v_mfma_f32_16x16x32_bf16 v[116:119], v[136:139], v[68:71], v[116:119]
    ds_read_b64_tr_b16 v[132:133], v10 offset:18432
    ds_read_b64_tr_b16 v[134:135], v10 offset:18944
    s_waitcnt lgkmcnt(15)
    v_mfma_f32_16x16x32_bf16 v[120:123], v[140:143], v[68:71], v[120:123]
    v_subrev_u32 v2, 129024, v2
    v_subrev_u32 v3, 129024, v3
    v_subrev_u32 v4, 129024, v4
    v_subrev_u32 v5, 129024, v5
    v_subrev_u32 v6, 129024, v6
    v_subrev_u32 v7, 129024, v7
    v_subrev_u32 v8, 129024, v8
    v_subrev_u32 v9, 129024, v9
    v_subrev_u32 v10, 129024, v10
    ds_read_b64_tr_b16 v[136:137], v2 offset:0
    ds_read_b64_tr_b16 v[138:139], v2 offset:4096
    s_waitcnt vmcnt(5)
    v_mfma_f32_16x16x32_bf16 v[88:91], a[216:219], v[40:43], v[88:91]
    v_mfma_f32_16x16x32_bf16 v[92:95], a[220:223], v[40:43], v[92:95]
    v_mfma_f32_16x16x32_bf16 v[96:99], a[224:227], v[40:43], v[96:99]
    v_mfma_f32_16x16x32_bf16 v[100:103], a[228:231], v[40:43], v[100:103]
    v_mfma_f32_16x16x32_bf16 v[104:107], a[232:235], v[40:43], v[104:107]
    v_mfma_f32_16x16x32_bf16 v[108:111], a[236:239], v[40:43], v[108:111]
    v_mfma_f32_16x16x32_bf16 v[112:115], a[240:243], v[40:43], v[112:115]
    v_mfma_f32_16x16x32_bf16 v[116:119], a[244:247], v[40:43], v[116:119]
    v_mfma_f32_16x16x32_bf16 v[120:123], a[248:251], v[40:43], v[120:123]
    s_waitcnt vmcnt(4)
    s_waitcnt lgkmcnt(15)
    v_mfma_f32_16x16x32_bf16 v[88:91], v[144:147], v[72:75], v[88:91]
    ds_read_b64_tr_b16 v[140:141], v3 offset:0
    ds_read_b64_tr_b16 v[142:143], v3 offset:4096
    s_waitcnt lgkmcnt(15)
    v_mfma_f32_16x16x32_bf16 v[92:95], v[148:151], v[72:75], v[92:95]
    ds_read_b64_tr_b16 v[144:145], v4 offset:0
    ds_read_b64_tr_b16 v[146:147], v4 offset:4096
    s_waitcnt lgkmcnt(15)
    v_mfma_f32_16x16x32_bf16 v[96:99], v[152:155], v[72:75], v[96:99]
    ds_read_b64_tr_b16 v[148:149], v5 offset:0
    ds_read_b64_tr_b16 v[150:151], v5 offset:4096
    s_waitcnt lgkmcnt(15)
    v_mfma_f32_16x16x32_bf16 v[100:103], v[156:159], v[72:75], v[100:103]
    ds_read_b64_tr_b16 v[152:153], v6 offset:0
    ds_read_b64_tr_b16 v[154:155], v6 offset:4096
    s_waitcnt lgkmcnt(15)
    v_mfma_f32_16x16x32_bf16 v[104:107], v[160:163], v[72:75], v[104:107]
    ds_read_b64_tr_b16 v[156:157], v7 offset:0
    ds_read_b64_tr_b16 v[158:159], v7 offset:4096
    s_waitcnt lgkmcnt(15)
    v_mfma_f32_16x16x32_bf16 v[108:111], v[164:167], v[72:75], v[108:111]
    ds_read_b64_tr_b16 v[160:161], v8 offset:0
    ds_read_b64_tr_b16 v[162:163], v8 offset:4096
    s_waitcnt lgkmcnt(15)
    v_mfma_f32_16x16x32_bf16 v[112:115], v[168:171], v[72:75], v[112:115]
    ds_read_b64_tr_b16 v[164:165], v9 offset:0
    ds_read_b64_tr_b16 v[166:167], v9 offset:4096
    s_waitcnt lgkmcnt(15)
    v_mfma_f32_16x16x32_bf16 v[116:119], v[172:175], v[72:75], v[116:119]
    ds_read_b64_tr_b16 v[168:169], v10 offset:0
    ds_read_b64_tr_b16 v[170:171], v10 offset:512
    s_waitcnt lgkmcnt(15)
    v_mfma_f32_16x16x32_bf16 v[120:123], v[176:179], v[72:75], v[120:123]
    s_waitcnt vmcnt(3)
    s_waitcnt lgkmcnt(15)
    v_mfma_f32_16x16x32_bf16 v[88:91], v[180:183], v[76:79], v[88:91]
    s_waitcnt lgkmcnt(15)
    v_mfma_f32_16x16x32_bf16 v[92:95], v[184:187], v[76:79], v[92:95]
    s_waitcnt lgkmcnt(15)
    v_mfma_f32_16x16x32_bf16 v[96:99], v[188:191], v[76:79], v[96:99]
    s_waitcnt lgkmcnt(15)
    v_mfma_f32_16x16x32_bf16 v[100:103], v[192:195], v[76:79], v[100:103]
    s_waitcnt lgkmcnt(15)
    v_mfma_f32_16x16x32_bf16 v[104:107], v[196:199], v[76:79], v[104:107]
    v_and_b32 v13, 15, v1
    s_lshl_b32 s63, s82, 4
    v_add_u32 v13, s63, v13
    v_lshlrev_b32 v13, 7, v13
    v_add_u32 v13, 786432, v13
    v_add_u32 v14, 262144, v13
    v_cmp_le_u32 vcc, 16, v1
    v_mov_b32 v15, s69
    v_mov_b32 v1, s69
    v_cndmask_b32 v13, v13, v14, vcc
    v_cndmask_b32 v15, v15, v1, vcc
    s_mov_b64 exec, s[56:57]
    buffer_load_dwordx2 v[0:1], v13, s[24:27], s79 offen sc1
    s_mov_b64 exec, -1
    s_waitcnt lgkmcnt(15)
    v_mfma_f32_16x16x32_bf16 v[108:111], v[200:203], v[76:79], v[108:111]
    s_waitcnt lgkmcnt(15)
    v_mfma_f32_16x16x32_bf16 v[112:115], v[204:207], v[76:79], v[112:115]
    s_waitcnt lgkmcnt(15)
    v_mfma_f32_16x16x32_bf16 v[116:119], v[208:211], v[76:79], v[116:119]
    s_waitcnt lgkmcnt(15)
    v_mfma_f32_16x16x32_bf16 v[120:123], v[212:215], v[76:79], v[120:123]
    s_waitcnt vmcnt(3)
    s_waitcnt lgkmcnt(15)
    v_mfma_f32_16x16x32_bf16 v[88:91], v[216:219], v[80:83], v[88:91]
    s_waitcnt lgkmcnt(15)
    v_mfma_f32_16x16x32_bf16 v[92:95], v[220:223], v[80:83], v[92:95]
    s_waitcnt lgkmcnt(15)
    v_mfma_f32_16x16x32_bf16 v[96:99], v[224:227], v[80:83], v[96:99]
    s_waitcnt lgkmcnt(15)
    v_mfma_f32_16x16x32_bf16 v[100:103], v[228:231], v[80:83], v[100:103]
    s_waitcnt lgkmcnt(15)
    v_mfma_f32_16x16x32_bf16 v[104:107], v[232:235], v[80:83], v[104:107]
    s_waitcnt lgkmcnt(15)
    v_mfma_f32_16x16x32_bf16 v[108:111], v[236:239], v[80:83], v[108:111]
    s_waitcnt lgkmcnt(15)
    v_mfma_f32_16x16x32_bf16 v[112:115], v[124:127], v[80:83], v[112:115]
    s_waitcnt lgkmcnt(15)
    v_mfma_f32_16x16x32_bf16 v[116:119], v[128:131], v[80:83], v[116:119]
    s_waitcnt lgkmcnt(15)
    v_mfma_f32_16x16x32_bf16 v[120:123], v[132:135], v[80:83], v[120:123]
    s_waitcnt vmcnt(2)
    s_waitcnt lgkmcnt(15)
    v_mfma_f32_16x16x32_bf16 v[88:91], v[136:139], v[84:87], v[88:91]
    s_waitcnt lgkmcnt(14)
    v_mfma_f32_16x16x32_bf16 v[92:95], v[140:143], v[84:87], v[92:95]
    s_waitcnt lgkmcnt(12)
    v_mfma_f32_16x16x32_bf16 v[96:99], v[144:147], v[84:87], v[96:99]
    s_waitcnt lgkmcnt(10)
    v_mfma_f32_16x16x32_bf16 v[100:103], v[148:151], v[84:87], v[100:103]
    s_waitcnt lgkmcnt(8)
    v_mfma_f32_16x16x32_bf16 v[104:107], v[152:155], v[84:87], v[104:107]
    s_waitcnt lgkmcnt(6)
    v_mfma_f32_16x16x32_bf16 v[108:111], v[156:159], v[84:87], v[108:111]
    s_waitcnt lgkmcnt(4)
    v_mfma_f32_16x16x32_bf16 v[112:115], v[160:163], v[84:87], v[112:115]
    s_waitcnt lgkmcnt(2)
    v_mfma_f32_16x16x32_bf16 v[116:119], v[164:167], v[84:87], v[116:119]
    s_waitcnt lgkmcnt(0)
    v_mfma_f32_16x16x32_bf16 v[120:123], v[168:171], v[84:87], v[120:123]
    s_waitcnt vmcnt(0)
    s_mov_b32 s76, 200000
L_wchk:
    s_mov_b64 exec, s[56:57]
    v_cmp_eq_u32 vcc, s68, v0
    v_cmp_eq_u32 s[4:5], v15, v1
    s_mov_b64 exec, -1
    s_and_b64 s[4:5], s[4:5], vcc
    s_lshr_b32 s5, s4, 16
    s_or_b32 s4, s4, s5
    s_and_b32 s4, s4, 0xffff
    s_cmp_eq_u32 s4, 0xffff
    s_cbranch_scc1 L_wok
    s_mov_b64 exec, s[56:57]
    buffer_load_dwordx2 v[0:1], v13, s[24:27], s79 offen sc1
    s_mov_b64 exec, -1
    s_waitcnt vmcnt(0)
    s_sub_u32 s76, s76, 1
    s_cmp_lg_u32 s76, 0
    s_cbranch_scc1 L_wchk
L_wok:
    s_nop 9
    v_cvt_pk_bf16_f32 v88, v88, v89
    v_cvt_pk_bf16_f32 v89, v90, v91
    ds_write_b64 v250, v[88:89] offset:0
    v_cvt_pk_bf16_f32 v92, v92, v93
    v_cvt_pk_bf16_f32 v93, v94, v95
    ds_write_b64 v250, v[92:93] offset:32
    v_cvt_pk_bf16_f32 v96, v96, v97
    v_cvt_pk_bf16_f32 v97, v98, v99
    ds_write_b64 v250, v[96:97] offset:64
    v_cvt_pk_bf16_f32 v100, v100, v101
    v_cvt_pk_bf16_f32 v101, v102, v103
    ds_write_b64 v250, v[100:101] offset:96
    v_cvt_pk_bf16_f32 v104, v104, v105
    v_cvt_pk_bf16_f32 v105, v106, v107
    ds_write_b64 v250, v[104:105] offset:128
    v_cvt_pk_bf16_f32 v108, v108, v109
    v_cvt_pk_bf16_f32 v109, v110, v111
    ds_write_b64 v250, v[108:109] offset:160
    v_cvt_pk_bf16_f32 v112, v112, v113
    v_cvt_pk_bf16_f32 v113, v114, v115
    ds_write_b64 v250, v[112:113] offset:192
    v_cvt_pk_bf16_f32 v116, v116, v117
    v_cvt_pk_bf16_f32 v117, v118, v119
    ds_write_b64 v250, v[116:117] offset:224
    v_cvt_pk_bf16_f32 v120, v120, v121
    v_cvt_pk_bf16_f32 v121, v122, v123
    ds_write_b64 v250, v[120:121] offset:256
    s_waitcnt lgkmcnt(0)
    ds_read_b128 v[32:35], v240
    ds_read_b128 v[36:39], v241
    ds_read_b128 v[40:43], v242
    ds_read_b128 v[44:47], v243
    s_mov_b64 exec, s[56:57]
    ds_read_b128 v[48:51], v244
    s_mov_b64 exec, -1
    s_waitcnt lgkmcnt(4)
    buffer_store_dwordx4 v[32:35], v245, s[20:23], s86 offen
    s_waitcnt lgkmcnt(3)
    buffer_store_dwordx4 v[36:39], v246, s[20:23], s86 offen
    s_waitcnt lgkmcnt(2)
    buffer_store_dwordx4 v[40:43], v247, s[20:23], s86 offen
    s_waitcnt lgkmcnt(1)
    buffer_store_dwordx4 v[44:47], v248, s[20:23], s86 offen
    s_waitcnt lgkmcnt(0)
    s_mov_b64 exec, s[56:57]
    buffer_store_dwordx4 v[48:51], v249, s[20:23], s86 offen
    s_mov_b64 exec, -1
    s_waitcnt vmcnt(0)
L_end:
    s_endpgm
L_slow:
    s_waitcnt vmcnt(0) lgkmcnt(0)
    v_and_b32 v84, 31, v1
    v_lshrrev_b32 v85, 5, v1
    v_lshlrev_b32 v85, 2, v85
    v_sub_u32 v84, v84, v85
    v_mov_b32 v86, 0xff800000
    v_mov_b32 v150, v86
    v_mfma_f32_32x32x16_bf16 v[52:67], v[92:95], a[0:3], 0
    v_mfma_f32_32x32x16_bf16 v[52:67], v[96:99], a[4:7], v[52:67]
    s_nop 15
    v_cmp_le_i32 vcc, 0, v84
    s_nop 1
    v_cndmask_b32 v52, v86, v52, vcc
    v_cmp_le_i32 vcc, 1, v84
    s_nop 1
    v_cndmask_b32 v53, v86, v53, vcc
    v_cmp_le_i32 vcc, 2, v84
    s_nop 1
    v_cndmask_b32 v54, v86, v54, vcc
    v_cmp_le_i32 vcc, 3, v84
    s_nop 1
    v_cndmask_b32 v55, v86, v55, vcc
    v_cmp_le_i32 vcc, 8, v84
    s_nop 1
    v_cndmask_b32 v56, v86, v56, vcc
    v_cmp_le_i32 vcc, 9, v84
    s_nop 1
    v_cndmask_b32 v57, v86, v57, vcc
    v_cmp_le_i32 vcc, 10, v84
    s_nop 1
    v_cndmask_b32 v58, v86, v58, vcc
    v_cmp_le_i32 vcc, 11, v84
    s_nop 1
    v_cndmask_b32 v59, v86, v59, vcc
    v_cmp_le_i32 vcc, 16, v84
    s_nop 1
    v_cndmask_b32 v60, v86, v60, vcc
    v_cmp_le_i32 vcc, 17, v84
    s_nop 1
    v_cndmask_b32 v61, v86, v61, vcc
    v_cmp_le_i32 vcc, 18, v84
    s_nop 1
    v_cndmask_b32 v62, v86, v62, vcc
    v_cmp_le_i32 vcc, 19, v84
    s_nop 1
    v_cndmask_b32 v63, v86, v63, vcc
    v_cmp_le_i32 vcc, 24, v84
    s_nop 1
    v_cndmask_b32 v64, v86, v64, vcc
    v_cmp_le_i32 vcc, 25, v84
    s_nop 1
    v_cndmask_b32 v65, v86, v65, vcc
    v_cmp_le_i32 vcc, 26, v84
    s_nop 1
    v_cndmask_b32 v66, v86, v66, vcc
    v_cmp_le_i32 vcc, 27, v84
    s_nop 1
    v_cndmask_b32 v67, v86, v67, vcc
    v_max3_f32 v150, v52, v53, v150
    v_max3_f32 v150, v54, v55, v150
    v_max3_f32 v150, v56, v57, v150
    v_max3_f32 v150, v58, v59, v150
    v_max3_f32 v150, v60, v61, v150
    v_max3_f32 v150, v62, v63, v150
    v_max3_f32 v150, v64, v65, v150
    v_max3_f32 v150, v66, v67, v150
    s_cmp_lt_u32 s33, 1
    s_cbranch_scc1 L_sk0_1
    v_mfma_f32_32x32x16_bf16 v[52:67], a[200:203], a[0:3], 0
    v_mfma_f32_32x32x16_bf16 v[52:67], a[204:207], a[4:7], v[52:67]
    s_nop 15
    v_max3_f32 v150, v52, v53, v150
    v_max3_f32 v150, v54, v55, v150
    v_max3_f32 v150, v56, v57, v150
    v_max3_f32 v150, v58, v59, v150
    v_max3_f32 v150, v60, v61, v150
    v_max3_f32 v150, v62, v63, v150
    v_max3_f32 v150, v64, v65, v150
    v_max3_f32 v150, v66, v67, v150
L_sk0_1:
    s_cmp_lt_u32 s33, 1
    s_cbranch_scc1 L_sk0_2
    v_mfma_f32_32x32x16_bf16 v[52:67], a[214:217], a[0:3], 0
    v_mfma_f32_32x32x16_bf16 v[52:67], a[218:221], a[4:7], v[52:67]
    s_nop 15
    v_max3_f32 v150, v52, v53, v150
    v_max3_f32 v150, v54, v55, v150
    v_max3_f32 v150, v56, v57, v150
    v_max3_f32 v150, v58, v59, v150
    v_max3_f32 v150, v60, v61, v150
    v_max3_f32 v150, v62, v63, v150
    v_max3_f32 v150, v64, v65, v150
    v_max3_f32 v150, v66, v67, v150
L_sk0_2:
    s_cmp_lt_u32 s33, 2
    s_cbranch_scc1 L_sk0_3
    v_mfma_f32_32x32x16_bf16 v[52:67], a[144:147], a[0:3], 0
    v_mfma_f32_32x32x16_bf16 v[52:67], a[148:151], a[4:7], v[52:67]
    s_nop 15
    v_cmp_gt_i32 vcc, 0, v84
    s_nop 1
    v_cndmask_b32 v52, v86, v52, vcc
    v_cmp_gt_i32 vcc, 1, v84
    s_nop 1
    v_cndmask_b32 v53, v86, v53, vcc
    v_cmp_gt_i32 vcc, 2, v84
    s_nop 1
    v_cndmask_b32 v54, v86, v54, vcc
    v_cmp_gt_i32 vcc, 3, v84
    s_nop 1
    v_cndmask_b32 v55, v86, v55, vcc
    v_cmp_gt_i32 vcc, 8, v84
    s_nop 1
    v_cndmask_b32 v56, v86, v56, vcc
    v_cmp_gt_i32 vcc, 9, v84
    s_nop 1
    v_cndmask_b32 v57, v86, v57, vcc
    v_cmp_gt_i32 vcc, 10, v84
    s_nop 1
    v_cndmask_b32 v58, v86, v58, vcc
    v_cmp_gt_i32 vcc, 11, v84
    s_nop 1
    v_cndmask_b32 v59, v86, v59, vcc
    v_cmp_gt_i32 vcc, 16, v84
    s_nop 1
    v_cndmask_b32 v60, v86, v60, vcc
    v_cmp_gt_i32 vcc, 17, v84
    s_nop 1
    v_cndmask_b32 v61, v86, v61, vcc
    v_cmp_gt_i32 vcc, 18, v84
    s_nop 1
    v_cndmask_b32 v62, v86, v62, vcc
    v_cmp_gt_i32 vcc, 19, v84
    s_nop 1
    v_cndmask_b32 v63, v86, v63, vcc
    v_cmp_gt_i32 vcc, 24, v84
    s_nop 1
    v_cndmask_b32 v64, v86, v64, vcc
    v_cmp_gt_i32 vcc, 25, v84
    s_nop 1
    v_cndmask_b32 v65, v86, v65, vcc
    v_cmp_gt_i32 vcc, 26, v84
    s_nop 1
    v_cndmask_b32 v66, v86, v66, vcc
    v_cmp_gt_i32 vcc, 27, v84
    s_nop 1
    v_cndmask_b32 v67, v86, v67, vcc
    v_max3_f32 v150, v52, v53, v150
    v_max3_f32 v150, v54, v55, v150
    v_max3_f32 v150, v56, v57, v150
    v_max3_f32 v150, v58, v59, v150
    v_max3_f32 v150, v60, v61, v150
    v_max3_f32 v150, v62, v63, v150
    v_max3_f32 v150, v64, v65, v150
    v_max3_f32 v150, v66, v67, v150
L_sk0_3:
    s_cmp_lt_u32 s33, 2
    s_cbranch_scc1 L_sk0_4
    v_mfma_f32_32x32x16_bf16 v[52:67], a[158:161], a[0:3], 0
    v_mfma_f32_32x32x16_bf16 v[52:67], a[162:165], a[4:7], v[52:67]
    s_nop 15
    v_max3_f32 v150, v52, v53, v150
    v_max3_f32 v150, v54, v55, v150
    v_max3_f32 v150, v56, v57, v150
    v_max3_f32 v150, v58, v59, v150
    v_max3_f32 v150, v60, v61, v150
    v_max3_f32 v150, v62, v63, v150
    v_max3_f32 v150, v64, v65, v150
    v_max3_f32 v150, v66, v67, v150
L_sk0_4:
    s_cmp_lt_u32 s33, 1
    s_cbranch_scc1 L_sk0_5
    v_mfma_f32_32x32x16_bf16 v[52:67], a[228:231], a[0:3], 0
    v_mfma_f32_32x32x16_bf16 v[52:67], a[232:235], a[4:7], v[52:67]
    s_nop 15
    v_max3_f32 v150, v52, v53, v150
    v_max3_f32 v150, v54, v55, v150
    v_max3_f32 v150, v56, v57, v150
    v_max3_f32 v150, v58, v59, v150
    v_max3_f32 v150, v60, v61, v150
    v_max3_f32 v150, v62, v63, v150
    v_max3_f32 v150, v64, v65, v150
    v_max3_f32 v150, v66, v67, v150
L_sk0_5:
    s_cmp_lt_u32 s33, 1
    s_cbranch_scc1 L_sk0_6
    v_mfma_f32_32x32x16_bf16 v[52:67], a[242:245], a[0:3], 0
    v_mfma_f32_32x32x16_bf16 v[52:67], a[246:249], a[4:7], v[52:67]
    s_nop 15
    v_max3_f32 v150, v52, v53, v150
    v_max3_f32 v150, v54, v55, v150
    v_max3_f32 v150, v56, v57, v150
    v_max3_f32 v150, v58, v59, v150
    v_max3_f32 v150, v60, v61, v150
    v_max3_f32 v150, v62, v63, v150
    v_max3_f32 v150, v64, v65, v150
    v_max3_f32 v150, v66, v67, v150
L_sk0_6:
    s_cmp_lt_u32 s33, 2
    s_cbranch_scc1 L_sk0_7
    v_mfma_f32_32x32x16_bf16 v[52:67], a[172:175], a[0:3], 0
    v_mfma_f32_32x32x16_bf16 v[52:67], a[176:179], a[4:7], v[52:67]
    s_nop 15
    v_max3_f32 v150, v52, v53, v150
    v_max3_f32 v150, v54, v55, v150
    v_max3_f32 v150, v56, v57, v150
    v_max3_f32 v150, v58, v59, v150
    v_max3_f32 v150, v60, v61, v150
    v_max3_f32 v150, v62, v63, v150
    v_max3_f32 v150, v64, v65, v150
    v_max3_f32 v150, v66, v67, v150
L_sk0_7:
    s_cmp_lt_u32 s33, 2
    s_cbranch_scc1 L_sk0_8
    v_mfma_f32_32x32x16_bf16 v[52:67], a[186:189], a[0:3], 0
    v_mfma_f32_32x32x16_bf16 v[52:67], a[190:193], a[4:7], v[52:67]
    s_nop 15
    v_max3_f32 v150, v52, v53, v150
    v_max3_f32 v150, v54, v55, v150
    v_max3_f32 v150, v56, v57, v150
    v_max3_f32 v150, v58, v59, v150
    v_max3_f32 v150, v60, v61, v150
    v_max3_f32 v150, v62, v63, v150
    v_max3_f32 v150, v64, v65, v150
    v_max3_f32 v150, v66, v67, v150
L_sk0_8:
    v_mov_b32 v87, v150
    s_nop 1
    v_permlane32_swap_b32 v150, v87
    s_nop 1
    v_max_f32 v150, v150, v87
    v_sub_f32 v87, 0, v150
    v_cvt_pk_bf16_f32 v88, v87, v87
    v_lshlrev_b32 v89, 16, v88
    v_sub_f32 v89, v87, v89
    v_cvt_pk_bf16_f32 v88, v87, v89
    s_mov_b64 exec, s[56:57]
    v_accvgpr_write_b32 a5, v88
    s_mov_b64 exec, -1
    v_mov_b32 v151, v86
    v_mfma_f32_32x32x16_bf16 v[52:67], v[92:95], a[8:11], 0
    v_mfma_f32_32x32x16_bf16 v[52:67], v[96:99], a[12:15], v[52:67]
    s_nop 15
    v_max3_f32 v151, v52, v53, v151
    v_max3_f32 v151, v54, v55, v151
    v_max3_f32 v151, v56, v57, v151
    v_max3_f32 v151, v58, v59, v151
    v_max3_f32 v151, v60, v61, v151
    v_max3_f32 v151, v62, v63, v151
    v_max3_f32 v151, v64, v65, v151
    v_max3_f32 v151, v66, v67, v151
    v_mfma_f32_32x32x16_bf16 v[52:67], v[106:109], a[8:11], 0
    v_mfma_f32_32x32x16_bf16 v[52:67], v[110:113], a[12:15], v[52:67]
    s_nop 15
    v_cmp_le_i32 vcc, 0, v84
    s_nop 1
    v_cndmask_b32 v52, v86, v52, vcc
    v_cmp_le_i32 vcc, 1, v84
    s_nop 1
    v_cndmask_b32 v53, v86, v53, vcc
    v_cmp_le_i32 vcc, 2, v84
    s_nop 1
    v_cndmask_b32 v54, v86, v54, vcc
    v_cmp_le_i32 vcc, 3, v84
    s_nop 1
    v_cndmask_b32 v55, v86, v55, vcc
    v_cmp_le_i32 vcc, 8, v84
    s_nop 1
    v_cndmask_b32 v56, v86, v56, vcc
    v_cmp_le_i32 vcc, 9, v84
    s_nop 1
    v_cndmask_b32 v57, v86, v57, vcc
    v_cmp_le_i32 vcc, 10, v84
    s_nop 1
    v_cndmask_b32 v58, v86, v58, vcc
    v_cmp_le_i32 vcc, 11, v84
    s_nop 1
    v_cndmask_b32 v59, v86, v59, vcc
    v_cmp_le_i32 vcc, 16, v84
    s_nop 1
    v_cndmask_b32 v60, v86, v60, vcc
    v_cmp_le_i32 vcc, 17, v84
    s_nop 1
    v_cndmask_b32 v61, v86, v61, vcc
    v_cmp_le_i32 vcc, 18, v84
    s_nop 1
    v_cndmask_b32 v62, v86, v62, vcc
    v_cmp_le_i32 vcc, 19, v84
    s_nop 1
    v_cndmask_b32 v63, v86, v63, vcc
    v_cmp_le_i32 vcc, 24, v84
    s_nop 1
    v_cndmask_b32 v64, v86, v64, vcc
    v_cmp_le_i32 vcc, 25, v84
    s_nop 1
    v_cndmask_b32 v65, v86, v65, vcc
    v_cmp_le_i32 vcc, 26, v84
    s_nop 1
    v_cndmask_b32 v66, v86, v66, vcc
    v_cmp_le_i32 vcc, 27, v84
    s_nop 1
    v_cndmask_b32 v67, v86, v67, vcc
    v_max3_f32 v151, v52, v53, v151
    v_max3_f32 v151, v54, v55, v151
    v_max3_f32 v151, v56, v57, v151
    v_max3_f32 v151, v58, v59, v151
    v_max3_f32 v151, v60, v61, v151
    v_max3_f32 v151, v62, v63, v151
    v_max3_f32 v151, v64, v65, v151
    v_max3_f32 v151, v66, v67, v151
    s_cmp_lt_u32 s33, 1
    s_cbranch_scc1 L_sk1_2
    v_mfma_f32_32x32x16_bf16 v[52:67], a[200:203], a[8:11], 0
    v_mfma_f32_32x32x16_bf16 v[52:67], a[204:207], a[12:15], v[52:67]
    s_nop 15
    v_max3_f32 v151, v52, v53, v151
    v_max3_f32 v151, v54, v55, v151
    v_max3_f32 v151, v56, v57, v151
    v_max3_f32 v151, v58, v59, v151
    v_max3_f32 v151, v60, v61, v151
    v_max3_f32 v151, v62, v63, v151
    v_max3_f32 v151, v64, v65, v151
    v_max3_f32 v151, v66, v67, v151
L_sk1_2:
    s_cmp_lt_u32 s33, 1
    s_cbranch_scc1 L_sk1_3
    v_mfma_f32_32x32x16_bf16 v[52:67], a[214:217], a[8:11], 0
    v_mfma_f32_32x32x16_bf16 v[52:67], a[218:221], a[12:15], v[52:67]
    s_nop 15
    v_max3_f32 v151, v52, v53, v151
    v_max3_f32 v151, v54, v55, v151
    v_max3_f32 v151, v56, v57, v151
    v_max3_f32 v151, v58, v59, v151
    v_max3_f32 v151, v60, v61, v151
    v_max3_f32 v151, v62, v63, v151
    v_max3_f32 v151, v64, v65, v151
    v_max3_f32 v151, v66, v67, v151
L_sk1_3:
    s_cmp_lt_u32 s33, 2
    s_cbranch_scc1 L_sk1_4
    v_mfma_f32_32x32x16_bf16 v[52:67], a[158:161], a[8:11], 0
    v_mfma_f32_32x32x16_bf16 v[52:67], a[162:165], a[12:15], v[52:67]
    s_nop 15
    v_cmp_gt_i32 vcc, 0, v84
    s_nop 1
    v_cndmask_b32 v52, v86, v52, vcc
    v_cmp_gt_i32 vcc, 1, v84
    s_nop 1
    v_cndmask_b32 v53, v86, v53, vcc
    v_cmp_gt_i32 vcc, 2, v84
    s_nop 1
    v_cndmask_b32 v54, v86, v54, vcc
    v_cmp_gt_i32 vcc, 3, v84
    s_nop 1
    v_cndmask_b32 v55, v86, v55, vcc
    v_cmp_gt_i32 vcc, 8, v84
    s_nop 1
    v_cndmask_b32 v56, v86, v56, vcc
    v_cmp_gt_i32 vcc, 9, v84
    s_nop 1
    v_cndmask_b32 v57, v86, v57, vcc
    v_cmp_gt_i32 vcc, 10, v84
    s_nop 1
    v_cndmask_b32 v58, v86, v58, vcc
    v_cmp_gt_i32 vcc, 11, v84
    s_nop 1
    v_cndmask_b32 v59, v86, v59, vcc
    v_cmp_gt_i32 vcc, 16, v84
    s_nop 1
    v_cndmask_b32 v60, v86, v60, vcc
    v_cmp_gt_i32 vcc, 17, v84
    s_nop 1
    v_cndmask_b32 v61, v86, v61, vcc
    v_cmp_gt_i32 vcc, 18, v84
    s_nop 1
    v_cndmask_b32 v62, v86, v62, vcc
    v_cmp_gt_i32 vcc, 19, v84
    s_nop 1
    v_cndmask_b32 v63, v86, v63, vcc
    v_cmp_gt_i32 vcc, 24, v84
    s_nop 1
    v_cndmask_b32 v64, v86, v64, vcc
    v_cmp_gt_i32 vcc, 25, v84
    s_nop 1
    v_cndmask_b32 v65, v86, v65, vcc
    v_cmp_gt_i32 vcc, 26, v84
    s_nop 1
    v_cndmask_b32 v66, v86, v66, vcc
    v_cmp_gt_i32 vcc, 27, v84
    s_nop 1
    v_cndmask_b32 v67, v86, v67, vcc
    v_max3_f32 v151, v52, v53, v151
    v_max3_f32 v151, v54, v55, v151
    v_max3_f32 v151, v56, v57, v151
    v_max3_f32 v151, v58, v59, v151
    v_max3_f32 v151, v60, v61, v151
    v_max3_f32 v151, v62, v63, v151
    v_max3_f32 v151, v64, v65, v151
    v_max3_f32 v151, v66, v67, v151
L_sk1_4:
    s_cmp_lt_u32 s33, 1
    s_cbranch_scc1 L_sk1_5
    v_mfma_f32_32x32x16_bf16 v[52:67], a[228:231], a[8:11], 0
    v_mfma_f32_32x32x16_bf16 v[52:67], a[232:235], a[12:15], v[52:67]
    s_nop 15
    v_max3_f32 v151, v52, v53, v151
    v_max3_f32 v151, v54, v55, v151
    v_max3_f32 v151, v56, v57, v151
    v_max3_f32 v151, v58, v59, v151
    v_max3_f32 v151, v60, v61, v151
    v_max3_f32 v151, v62, v63, v151
    v_max3_f32 v151, v64, v65, v151
    v_max3_f32 v151, v66, v67, v151
L_sk1_5:
    s_cmp_lt_u32 s33, 1
    s_cbranch_scc1 L_sk1_6
    v_mfma_f32_32x32x16_bf16 v[52:67], a[242:245], a[8:11], 0
    v_mfma_f32_32x32x16_bf16 v[52:67], a[246:249], a[12:15], v[52:67]
    s_nop 15
    v_max3_f32 v151, v52, v53, v151
    v_max3_f32 v151, v54, v55, v151
    v_max3_f32 v151, v56, v57, v151
    v_max3_f32 v151, v58, v59, v151
    v_max3_f32 v151, v60, v61, v151
    v_max3_f32 v151, v62, v63, v151
    v_max3_f32 v151, v64, v65, v151
    v_max3_f32 v151, v66, v67, v151
L_sk1_6:
    s_cmp_lt_u32 s33, 2
    s_cbranch_scc1 L_sk1_7
    v_mfma_f32_32x32x16_bf16 v[52:67], a[172:175], a[8:11], 0
    v_mfma_f32_32x32x16_bf16 v[52:67], a[176:179], a[12:15], v[52:67]
    s_nop 15
    v_max3_f32 v151, v52, v53, v151
    v_max3_f32 v151, v54, v55, v151
    v_max3_f32 v151, v56, v57, v151
    v_max3_f32 v151, v58, v59, v151
    v_max3_f32 v151, v60, v61, v151
    v_max3_f32 v151, v62, v63, v151
    v_max3_f32 v151, v64, v65, v151
    v_max3_f32 v151, v66, v67, v151
L_sk1_7:
    s_cmp_lt_u32 s33, 2
    s_cbranch_scc1 L_sk1_8
    v_mfma_f32_32x32x16_bf16 v[52:67], a[186:189], a[8:11], 0
    v_mfma_f32_32x32x16_bf16 v[52:67], a[190:193], a[12:15], v[52:67]
    s_nop 15
    v_max3_f32 v151, v52, v53, v151
    v_max3_f32 v151, v54, v55, v151
    v_max3_f32 v151, v56, v57, v151
    v_max3_f32 v151, v58, v59, v151
    v_max3_f32 v151, v60, v61, v151
    v_max3_f32 v151, v62, v63, v151
    v_max3_f32 v151, v64, v65, v151
    v_max3_f32 v151, v66, v67, v151
L_sk1_8:
    v_mov_b32 v87, v151
    s_nop 1
    v_permlane32_swap_b32 v151, v87
    s_nop 1
    v_max_f32 v151, v151, v87
    v_sub_f32 v87, 0, v151
    v_cvt_pk_bf16_f32 v88, v87, v87
    v_lshlrev_b32 v89, 16, v88
    v_sub_f32 v89, v87, v89
    v_cvt_pk_bf16_f32 v88, v87, v89
    s_mov_b64 exec, s[56:57]
    v_accvgpr_write_b32 a13, v88
    s_mov_b64 exec, -1
    v_mov_b32 v152, v86
    v_mfma_f32_32x32x16_bf16 v[52:67], v[92:95], a[16:19], 0
    v_mfma_f32_32x32x16_bf16 v[52:67], v[96:99], a[20:23], v[52:67]
    s_nop 15
    v_max3_f32 v152, v52, v53, v152
    v_max3_f32 v152, v54, v55, v152
    v_max3_f32 v152, v56, v57, v152
    v_max3_f32 v152, v58, v59, v152
    v_max3_f32 v152, v60, v61, v152
    v_max3_f32 v152, v62, v63, v152
    v_max3_f32 v152, v64, v65, v152
    v_max3_f32 v152, v66, v67, v152
    v_mfma_f32_32x32x16_bf16 v[52:67], v[106:109], a[16:19], 0
    v_mfma_f32_32x32x16_bf16 v[52:67], v[110:113], a[20:23], v[52:67]
    s_nop 15
    v_max3_f32 v152, v52, v53, v152
    v_max3_f32 v152, v54, v55, v152
    v_max3_f32 v152, v56, v57, v152
    v_max3_f32 v152, v58, v59, v152
    v_max3_f32 v152, v60, v61, v152
    v_max3_f32 v152, v62, v63, v152
    v_max3_f32 v152, v64, v65, v152
    v_max3_f32 v152, v66, v67, v152
    v_mfma_f32_32x32x16_bf16 v[52:67], v[120:123], a[16:19], 0
    v_mfma_f32_32x32x16_bf16 v[52:67], v[124:127], a[20:23], v[52:67]
    s_nop 15
    v_cmp_le_i32 vcc, 0, v84
    s_nop 1
    v_cndmask_b32 v52, v86, v52, vcc
    v_cmp_le_i32 vcc, 1, v84
    s_nop 1
    v_cndmask_b32 v53, v86, v53, vcc
    v_cmp_le_i32 vcc, 2, v84
    s_nop 1
    v_cndmask_b32 v54, v86, v54, vcc
    v_cmp_le_i32 vcc, 3, v84
    s_nop 1
    v_cndmask_b32 v55, v86, v55, vcc
    v_cmp_le_i32 vcc, 8, v84
    s_nop 1
    v_cndmask_b32 v56, v86, v56, vcc
    v_cmp_le_i32 vcc, 9, v84
    s_nop 1
    v_cndmask_b32 v57, v86, v57, vcc
    v_cmp_le_i32 vcc, 10, v84
    s_nop 1
    v_cndmask_b32 v58, v86, v58, vcc
    v_cmp_le_i32 vcc, 11, v84
    s_nop 1
    v_cndmask_b32 v59, v86, v59, vcc
    v_cmp_le_i32 vcc, 16, v84
    s_nop 1
    v_cndmask_b32 v60, v86, v60, vcc
    v_cmp_le_i32 vcc, 17, v84
    s_nop 1
    v_cndmask_b32 v61, v86, v61, vcc
    v_cmp_le_i32 vcc, 18, v84
    s_nop 1
    v_cndmask_b32 v62, v86, v62, vcc
    v_cmp_le_i32 vcc, 19, v84
    s_nop 1
    v_cndmask_b32 v63, v86, v63, vcc
    v_cmp_le_i32 vcc, 24, v84
    s_nop 1
    v_cndmask_b32 v64, v86, v64, vcc
    v_cmp_le_i32 vcc, 25, v84
    s_nop 1
    v_cndmask_b32 v65, v86, v65, vcc
    v_cmp_le_i32 vcc, 26, v84
    s_nop 1
    v_cndmask_b32 v66, v86, v66, vcc
    v_cmp_le_i32 vcc, 27, v84
    s_nop 1
    v_cndmask_b32 v67, v86, v67, vcc
    v_max3_f32 v152, v52, v53, v152
    v_max3_f32 v152, v54, v55, v152
    v_max3_f32 v152, v56, v57, v152
    v_max3_f32 v152, v58, v59, v152
    v_max3_f32 v152, v60, v61, v152
    v_max3_f32 v152, v62, v63, v152
    v_max3_f32 v152, v64, v65, v152
    v_max3_f32 v152, v66, v67, v152
    s_cmp_lt_u32 s33, 1
    s_cbranch_scc1 L_sk2_3
    v_mfma_f32_32x32x16_bf16 v[52:67], a[200:203], a[16:19], 0
    v_mfma_f32_32x32x16_bf16 v[52:67], a[204:207], a[20:23], v[52:67]
    s_nop 15
    v_max3_f32 v152, v52, v53, v152
    v_max3_f32 v152, v54, v55, v152
    v_max3_f32 v152, v56, v57, v152
    v_max3_f32 v152, v58, v59, v152
    v_max3_f32 v152, v60, v61, v152
    v_max3_f32 v152, v62, v63, v152
    v_max3_f32 v152, v64, v65, v152
    v_max3_f32 v152, v66, v67, v152
L_sk2_3:
    s_cmp_lt_u32 s33, 1
    s_cbranch_scc1 L_sk2_4
    v_mfma_f32_32x32x16_bf16 v[52:67], a[214:217], a[16:19], 0
    v_mfma_f32_32x32x16_bf16 v[52:67], a[218:221], a[20:23], v[52:67]
    s_nop 15
    v_max3_f32 v152, v52, v53, v152
    v_max3_f32 v152, v54, v55, v152
    v_max3_f32 v152, v56, v57, v152
    v_max3_f32 v152, v58, v59, v152
    v_max3_f32 v152, v60, v61, v152
    v_max3_f32 v152, v62, v63, v152
    v_max3_f32 v152, v64, v65, v152
    v_max3_f32 v152, v66, v67, v152
L_sk2_4:
    s_cmp_lt_u32 s33, 1
    s_cbranch_scc1 L_sk2_5
    v_mfma_f32_32x32x16_bf16 v[52:67], a[228:231], a[16:19], 0
    v_mfma_f32_32x32x16_bf16 v[52:67], a[232:235], a[20:23], v[52:67]
    s_nop 15
    v_max3_f32 v152, v52, v53, v152
    v_max3_f32 v152, v54, v55, v152
    v_max3_f32 v152, v56, v57, v152
    v_max3_f32 v152, v58, v59, v152
    v_max3_f32 v152, v60, v61, v152
    v_max3_f32 v152, v62, v63, v152
    v_max3_f32 v152, v64, v65, v152
    v_max3_f32 v152, v66, v67, v152
L_sk2_5:
    s_cmp_lt_u32 s33, 1
    s_cbranch_scc1 L_sk2_6
    v_mfma_f32_32x32x16_bf16 v[52:67], a[242:245], a[16:19], 0
    v_mfma_f32_32x32x16_bf16 v[52:67], a[246:249], a[20:23], v[52:67]
    s_nop 15
    v_max3_f32 v152, v52, v53, v152
    v_max3_f32 v152, v54, v55, v152
    v_max3_f32 v152, v56, v57, v152
    v_max3_f32 v152, v58, v59, v152
    v_max3_f32 v152, v60, v61, v152
    v_max3_f32 v152, v62, v63, v152
    v_max3_f32 v152, v64, v65, v152
    v_max3_f32 v152, v66, v67, v152
L_sk2_6:
    s_cmp_lt_u32 s33, 2
    s_cbranch_scc1 L_sk2_7
    v_mfma_f32_32x32x16_bf16 v[52:67], a[172:175], a[16:19], 0
    v_mfma_f32_32x32x16_bf16 v[52:67], a[176:179], a[20:23], v[52:67]
    s_nop 15
    v_cmp_gt_i32 vcc, 0, v84
    s_nop 1
    v_cndmask_b32 v52, v86, v52, vcc
    v_cmp_gt_i32 vcc, 1, v84
    s_nop 1
    v_cndmask_b32 v53, v86, v53, vcc
    v_cmp_gt_i32 vcc, 2, v84
    s_nop 1
    v_cndmask_b32 v54, v86, v54, vcc
    v_cmp_gt_i32 vcc, 3, v84
    s_nop 1
    v_cndmask_b32 v55, v86, v55, vcc
    v_cmp_gt_i32 vcc, 8, v84
    s_nop 1
    v_cndmask_b32 v56, v86, v56, vcc
    v_cmp_gt_i32 vcc, 9, v84
    s_nop 1
    v_cndmask_b32 v57, v86, v57, vcc
    v_cmp_gt_i32 vcc, 10, v84
    s_nop 1
    v_cndmask_b32 v58, v86, v58, vcc
    v_cmp_gt_i32 vcc, 11, v84
    s_nop 1
    v_cndmask_b32 v59, v86, v59, vcc
    v_cmp_gt_i32 vcc, 16, v84
    s_nop 1
    v_cndmask_b32 v60, v86, v60, vcc
    v_cmp_gt_i32 vcc, 17, v84
    s_nop 1
    v_cndmask_b32 v61, v86, v61, vcc
    v_cmp_gt_i32 vcc, 18, v84
    s_nop 1
    v_cndmask_b32 v62, v86, v62, vcc
    v_cmp_gt_i32 vcc, 19, v84
    s_nop 1
    v_cndmask_b32 v63, v86, v63, vcc
    v_cmp_gt_i32 vcc, 24, v84
    s_nop 1
    v_cndmask_b32 v64, v86, v64, vcc
    v_cmp_gt_i32 vcc, 25, v84
    s_nop 1
    v_cndmask_b32 v65, v86, v65, vcc
    v_cmp_gt_i32 vcc, 26, v84
    s_nop 1
    v_cndmask_b32 v66, v86, v66, vcc
    v_cmp_gt_i32 vcc, 27, v84
    s_nop 1
    v_cndmask_b32 v67, v86, v67, vcc
    v_max3_f32 v152, v52, v53, v152
    v_max3_f32 v152, v54, v55, v152
    v_max3_f32 v152, v56, v57, v152
    v_max3_f32 v152, v58, v59, v152
    v_max3_f32 v152, v60, v61, v152
    v_max3_f32 v152, v62, v63, v152
    v_max3_f32 v152, v64, v65, v152
    v_max3_f32 v152, v66, v67, v152
L_sk2_7:
    s_cmp_lt_u32 s33, 2
    s_cbranch_scc1 L_sk2_8
    v_mfma_f32_32x32x16_bf16 v[52:67], a[186:189], a[16:19], 0
    v_mfma_f32_32x32x16_bf16 v[52:67], a[190:193], a[20:23], v[52:67]
    s_nop 15
    v_max3_f32 v152, v52, v53, v152
    v_max3_f32 v152, v54, v55, v152
    v_max3_f32 v152, v56, v57, v152
    v_max3_f32 v152, v58, v59, v152
    v_max3_f32 v152, v60, v61, v152
    v_max3_f32 v152, v62, v63, v152
    v_max3_f32 v152, v64, v65, v152
    v_max3_f32 v152, v66, v67, v152
L_sk2_8:
    v_mov_b32 v87, v152
    s_nop 1
    v_permlane32_swap_b32 v152, v87
    s_nop 1
    v_max_f32 v152, v152, v87
    v_sub_f32 v87, 0, v152
    v_cvt_pk_bf16_f32 v88, v87, v87
    v_lshlrev_b32 v89, 16, v88
    v_sub_f32 v89, v87, v89
    v_cvt_pk_bf16_f32 v88, v87, v89
    s_mov_b64 exec, s[56:57]
    v_accvgpr_write_b32 a21, v88
    s_mov_b64 exec, -1
    v_mov_b32 v153, v86
    v_mfma_f32_32x32x16_bf16 v[52:67], v[92:95], a[24:27], 0
    v_mfma_f32_32x32x16_bf16 v[52:67], v[96:99], a[28:31], v[52:67]
    s_nop 15
    v_max3_f32 v153, v52, v53, v153
    v_max3_f32 v153, v54, v55, v153
    v_max3_f32 v153, v56, v57, v153
    v_max3_f32 v153, v58, v59, v153
    v_max3_f32 v153, v60, v61, v153
    v_max3_f32 v153, v62, v63, v153
    v_max3_f32 v153, v64, v65, v153
    v_max3_f32 v153, v66, v67, v153
    v_mfma_f32_32x32x16_bf16 v[52:67], v[106:109], a[24:27], 0
    v_mfma_f32_32x32x16_bf16 v[52:67], v[110:113], a[28:31], v[52:67]
    s_nop 15
    v_max3_f32 v153, v52, v53, v153
    v_max3_f32 v153, v54, v55, v153
    v_max3_f32 v153, v56, v57, v153
    v_max3_f32 v153, v58, v59, v153
    v_max3_f32 v153, v60, v61, v153
    v_max3_f32 v153, v62, v63, v153
    v_max3_f32 v153, v64, v65, v153
    v_max3_f32 v153, v66, v67, v153
    v_mfma_f32_32x32x16_bf16 v[52:67], v[120:123], a[24:27], 0
    v_mfma_f32_32x32x16_bf16 v[52:67], v[124:127], a[28:31], v[52:67]
    s_nop 15
    v_max3_f32 v153, v52, v53, v153
    v_max3_f32 v153, v54, v55, v153
    v_max3_f32 v153, v56, v57, v153
    v_max3_f32 v153, v58, v59, v153
    v_max3_f32 v153, v60, v61, v153
    v_max3_f32 v153, v62, v63, v153
    v_max3_f32 v153, v64, v65, v153
    v_max3_f32 v153, v66, v67, v153
    v_mfma_f32_32x32x16_bf16 v[52:67], v[134:137], a[24:27], 0
    v_mfma_f32_32x32x16_bf16 v[52:67], v[138:141], a[28:31], v[52:67]
    s_nop 15
    v_cmp_le_i32 vcc, 0, v84
    s_nop 1
    v_cndmask_b32 v52, v86, v52, vcc
    v_cmp_le_i32 vcc, 1, v84
    s_nop 1
    v_cndmask_b32 v53, v86, v53, vcc
    v_cmp_le_i32 vcc, 2, v84
    s_nop 1
    v_cndmask_b32 v54, v86, v54, vcc
    v_cmp_le_i32 vcc, 3, v84
    s_nop 1
    v_cndmask_b32 v55, v86, v55, vcc
    v_cmp_le_i32 vcc, 8, v84
    s_nop 1
    v_cndmask_b32 v56, v86, v56, vcc
    v_cmp_le_i32 vcc, 9, v84
    s_nop 1
    v_cndmask_b32 v57, v86, v57, vcc
    v_cmp_le_i32 vcc, 10, v84
    s_nop 1
    v_cndmask_b32 v58, v86, v58, vcc
    v_cmp_le_i32 vcc, 11, v84
    s_nop 1
    v_cndmask_b32 v59, v86, v59, vcc
    v_cmp_le_i32 vcc, 16, v84
    s_nop 1
    v_cndmask_b32 v60, v86, v60, vcc
    v_cmp_le_i32 vcc, 17, v84
    s_nop 1
    v_cndmask_b32 v61, v86, v61, vcc
    v_cmp_le_i32 vcc, 18, v84
    s_nop 1
    v_cndmask_b32 v62, v86, v62, vcc
    v_cmp_le_i32 vcc, 19, v84
    s_nop 1
    v_cndmask_b32 v63, v86, v63, vcc
    v_cmp_le_i32 vcc, 24, v84
    s_nop 1
    v_cndmask_b32 v64, v86, v64, vcc
    v_cmp_le_i32 vcc, 25, v84
    s_nop 1
    v_cndmask_b32 v65, v86, v65, vcc
    v_cmp_le_i32 vcc, 26, v84
    s_nop 1
    v_cndmask_b32 v66, v86, v66, vcc
    v_cmp_le_i32 vcc, 27, v84
    s_nop 1
    v_cndmask_b32 v67, v86, v67, vcc
    v_max3_f32 v153, v52, v53, v153
    v_max3_f32 v153, v54, v55, v153
    v_max3_f32 v153, v56, v57, v153
    v_max3_f32 v153, v58, v59, v153
    v_max3_f32 v153, v60, v61, v153
    v_max3_f32 v153, v62, v63, v153
    v_max3_f32 v153, v64, v65, v153
    v_max3_f32 v153, v66, v67, v153
    s_cmp_lt_u32 s33, 1
    s_cbranch_scc1 L_sk3_4
    v_mfma_f32_32x32x16_bf16 v[52:67], a[200:203], a[24:27], 0
    v_mfma_f32_32x32x16_bf16 v[52:67], a[204:207], a[28:31], v[52:67]
    s_nop 15
    v_max3_f32 v153, v52, v53, v153
    v_max3_f32 v153, v54, v55, v153
    v_max3_f32 v153, v56, v57, v153
    v_max3_f32 v153, v58, v59, v153
    v_max3_f32 v153, v60, v61, v153
    v_max3_f32 v153, v62, v63, v153
    v_max3_f32 v153, v64, v65, v153
    v_max3_f32 v153, v66, v67, v153
L_sk3_4:
    s_cmp_lt_u32 s33, 1
    s_cbranch_scc1 L_sk3_5
    v_mfma_f32_32x32x16_bf16 v[52:67], a[214:217], a[24:27], 0
    v_mfma_f32_32x32x16_bf16 v[52:67], a[218:221], a[28:31], v[52:67]
    s_nop 15
    v_max3_f32 v153, v52, v53, v153
    v_max3_f32 v153, v54, v55, v153
    v_max3_f32 v153, v56, v57, v153
    v_max3_f32 v153, v58, v59, v153
    v_max3_f32 v153, v60, v61, v153
    v_max3_f32 v153, v62, v63, v153
    v_max3_f32 v153, v64, v65, v153
    v_max3_f32 v153, v66, v67, v153
L_sk3_5:
    s_cmp_lt_u32 s33, 1
    s_cbranch_scc1 L_sk3_6
    v_mfma_f32_32x32x16_bf16 v[52:67], a[228:231], a[24:27], 0
    v_mfma_f32_32x32x16_bf16 v[52:67], a[232:235], a[28:31], v[52:67]
    s_nop 15
    v_max3_f32 v153, v52, v53, v153
    v_max3_f32 v153, v54, v55, v153
    v_max3_f32 v153, v56, v57, v153
    v_max3_f32 v153, v58, v59, v153
    v_max3_f32 v153, v60, v61, v153
    v_max3_f32 v153, v62, v63, v153
    v_max3_f32 v153, v64, v65, v153
    v_max3_f32 v153, v66, v67, v153
L_sk3_6:
    s_cmp_lt_u32 s33, 1
    s_cbranch_scc1 L_sk3_7
    v_mfma_f32_32x32x16_bf16 v[52:67], a[242:245], a[24:27], 0
    v_mfma_f32_32x32x16_bf16 v[52:67], a[246:249], a[28:31], v[52:67]
    s_nop 15
    v_max3_f32 v153, v52, v53, v153
    v_max3_f32 v153, v54, v55, v153
    v_max3_f32 v153, v56, v57, v153
    v_max3_f32 v153, v58, v59, v153
    v_max3_f32 v153, v60, v61, v153
    v_max3_f32 v153, v62, v63, v153
    v_max3_f32 v153, v64, v65, v153
    v_max3_f32 v153, v66, v67, v153
L_sk3_7:
    s_cmp_lt_u32 s33, 2
    s_cbranch_scc1 L_sk3_8
    v_mfma_f32_32x32x16_bf16 v[52:67], a[186:189], a[24:27], 0
    v_mfma_f32_32x32x16_bf16 v[52:67], a[190:193], a[28:31], v[52:67]
    s_nop 15
    v_cmp_gt_i32 vcc, 0, v84
    s_nop 1
    v_cndmask_b32 v52, v86, v52, vcc
    v_cmp_gt_i32 vcc, 1, v84
    s_nop 1
    v_cndmask_b32 v53, v86, v53, vcc
    v_cmp_gt_i32 vcc, 2, v84
    s_nop 1
    v_cndmask_b32 v54, v86, v54, vcc
    v_cmp_gt_i32 vcc, 3, v84
    s_nop 1
    v_cndmask_b32 v55, v86, v55, vcc
    v_cmp_gt_i32 vcc, 8, v84
    s_nop 1
    v_cndmask_b32 v56, v86, v56, vcc
    v_cmp_gt_i32 vcc, 9, v84
    s_nop 1
    v_cndmask_b32 v57, v86, v57, vcc
    v_cmp_gt_i32 vcc, 10, v84
    s_nop 1
    v_cndmask_b32 v58, v86, v58, vcc
    v_cmp_gt_i32 vcc, 11, v84
    s_nop 1
    v_cndmask_b32 v59, v86, v59, vcc
    v_cmp_gt_i32 vcc, 16, v84
    s_nop 1
    v_cndmask_b32 v60, v86, v60, vcc
    v_cmp_gt_i32 vcc, 17, v84
    s_nop 1
    v_cndmask_b32 v61, v86, v61, vcc
    v_cmp_gt_i32 vcc, 18, v84
    s_nop 1
    v_cndmask_b32 v62, v86, v62, vcc
    v_cmp_gt_i32 vcc, 19, v84
    s_nop 1
    v_cndmask_b32 v63, v86, v63, vcc
    v_cmp_gt_i32 vcc, 24, v84
    s_nop 1
    v_cndmask_b32 v64, v86, v64, vcc
    v_cmp_gt_i32 vcc, 25, v84
    s_nop 1
    v_cndmask_b32 v65, v86, v65, vcc
    v_cmp_gt_i32 vcc, 26, v84
    s_nop 1
    v_cndmask_b32 v66, v86, v66, vcc
    v_cmp_gt_i32 vcc, 27, v84
    s_nop 1
    v_cndmask_b32 v67, v86, v67, vcc
    v_max3_f32 v153, v52, v53, v153
    v_max3_f32 v153, v54, v55, v153
    v_max3_f32 v153, v56, v57, v153
    v_max3_f32 v153, v58, v59, v153
    v_max3_f32 v153, v60, v61, v153
    v_max3_f32 v153, v62, v63, v153
    v_max3_f32 v153, v64, v65, v153
    v_max3_f32 v153, v66, v67, v153
L_sk3_8:
    v_mov_b32 v87, v153
    s_nop 1
    v_permlane32_swap_b32 v153, v87
    s_nop 1
    v_max_f32 v153, v153, v87
    v_sub_f32 v87, 0, v153
    v_cvt_pk_bf16_f32 v88, v87, v87
    v_lshlrev_b32 v89, 16, v88
    v_sub_f32 v89, v87, v89
    v_cvt_pk_bf16_f32 v88, v87, v89
    s_mov_b64 exec, s[56:57]
    v_accvgpr_write_b32 a29, v88
    s_mov_b64 exec, -1
    s_mov_b32 s52, 1
    s_mov_b64 s[74:75], 0
    s_nop 3
    s_branch L_att
.section .rodata,"a"
.p2align 6
.amdhsa_kernel concat_heads__sliding_block__sliding_block__prompt_kernel
  .amdhsa_next_free_vgpr 512
  .amdhsa_next_free_sgpr 102
  .amdhsa_accum_offset 256
  .amdhsa_group_segment_fixed_size 0
  .amdhsa_kernarg_size 72
  .amdhsa_user_sgpr_count 2
  .amdhsa_user_sgpr_kernarg_segment_ptr 1
  .amdhsa_system_sgpr_workgroup_id_x 1
.end_amdhsa_kernel
```
